```python
import torch

def _softmax(x, axis=-1):
    return torch.softmax(x, dim=axis)
def _gelu(x):
    return torch.nn.functional.gelu(x, approximate="tanh")
def _silu(x):
    return torch.nn.functional.silu(x)
def _sigmoid(x):
    return torch.sigmoid(x)
def _layernorm(x, axis=-1, eps=1e-5):
    m = x.mean(dim=axis, keepdim=True)
    v = x.var(dim=axis, keepdim=True, unbiased=False)
    return (x - m) / torch.sqrt(v + eps)
def _scatter_add(tgt, idx, src, axis=0):
    return tgt.clone().index_add_(axis, idx, src)
def _segment_sum(src, seg, n):
    out = torch.zeros((n,) + src.shape[1:], dtype=src.dtype)
    return out.index_add_(0, seg, src)
def _pad(x, pw):
    flat = tuple(v for pair in reversed(pw) for v in pair)
    return torch.nn.functional.pad(x, flat)

kernel_name = 'standalone__gqa_block_cached__near_ridge'

def setup_inputs():

    _w = (lambda a: (lambda t: t.to(torch.bfloat16) if t.is_floating_point() else t)(torch.as_tensor(a)))
    B, Sq, D = 16, 64, 512
    Hq, Hkv, Sk, Dh = 32, 32, 64, 128
    assert Hq % Hkv == 0, (Hq, Hkv)
    return {
        "x": _w((lambda *s: torch.randn(*s, dtype=torch.bfloat16) * 0.8)(B, Sq, D)),
        "k_cache": _w((lambda *s: torch.randn(*s, dtype=torch.bfloat16) * 0.8)(B, Hkv, Sk, Dh)),
        "v_cache": _w((lambda *s: torch.randn(*s, dtype=torch.bfloat16) * 0.05)(B, Hkv, Sk, Dh)),
        "wq": _w((lambda *s: torch.randn(*s, dtype=torch.bfloat16) * 0.8)(D, Hq * Dh) * (D ** -0.5)),
        "wo": _w((lambda *s: torch.randn(*s, dtype=torch.bfloat16) * 0.05)(Hq * Dh, D) * ((Hq * Dh) ** -0.5)),
    }

def reference(x, k_cache, v_cache, wq, wo):
    B, Sq, D = x.shape
    Hq, Dh = 32, 128
    Hkv = k_cache.shape[1]
    rep = Hq // Hkv
    q = (lambda x, *d: x.permute(*d))((x @ wq).reshape(B, Sq, Hq, Dh), 0, 2, 1, 3)
    k = (lambda x, n, axis: torch.repeat_interleave(x, n, dim=axis))(k_cache, rep, axis=1)
    v = (lambda x, n, axis: torch.repeat_interleave(x, n, dim=axis))(v_cache, rep, axis=1)
    scores = torch.einsum("bhqd,bhkd->bhqk", q, k) * (Dh ** -0.5)
    p = _softmax(scores, axis=-1)
    o = torch.einsum("bhqk,bhkd->bhqd", p, v)
    return (lambda x, *d: x.permute(*d))(o, 0, 2, 1, 3).reshape(B, Sq, Hq * Dh) @ wo
```

```asm
; @launch grid=(256,1,1) block=(512,1,1) lds=163840
.amdgcn_target "amdgcn-amd-amdhsa--gfx950"
.text
.globl standalone__gqa_block_cached__near_ridge_kernel
.p2align 8
.type standalone__gqa_block_cached__near_ridge_kernel,@function
standalone__gqa_block_cached__near_ridge_kernel:
  s_cmp_ge_u32 s2, 256
  s_cbranch_scc1 L_END
  s_load_dwordx16 s[16:31], s[0:1], 0
  s_getpc_b64 s[92:93]
  s_bfe_u32 s9, s2, 0x30003
  s_lshl_b32 s9, s9, 12
  v_lshl_add_u32 v1, v0, 4, s9
  v_cmp_gt_u32 vcc, CODE_BYTES, v1
  s_and_saveexec_b64 s[56:57], vcc
  s_cbranch_execz L_NOCPF
  v_cmp_gt_u32 vcc, 0x100, v0
  s_and_b64 exec, exec, vcc
  s_cbranch_execz L_NOCPF
  global_load_dwordx4 v[252:255], v1, s[92:93]
L_NOCPF:
  s_mov_b64 exec, -1
  v_lshrrev_b32 v1, 6, v0
  v_and_b32 v0, 63, v0
  v_readfirstlane_b32 s3, v1
  v_mov_b32 v31, 162816
  v_mov_b32 v30, 1
  s_mov_b32 s14, 4194304
  s_and_b32 s4, s2, 3
  s_bfe_u32 s9, s2, 0x10002
  s_bfe_u32 s6, s2, 0x30003
  s_lshr_b32 s13, s2, 6
  s_lshl_b32 s5, s9, 2
  s_add_u32 s5, s5, s13
  s_lshl_b32 s7, s4, 3
  s_add_u32 s7, s7, s6
  s_and_b32 s15, s13, 1
  s_mul_i32 s15, s15, 6
  s_add_u32 s15, s15, 1
  s_and_b32 s9, s3, 6
  s_cmp_lg_u32 s9, 4
  s_cbranch_scc1 L_OTHER
  s_add_u32 s8, s13, s6
  s_and_b32 s8, s8, 0
  s_mul_i32 s8, s8, 8
  s_and_b32 s45, s3, 1
  v_lshrrev_b32 v1, 4, v0
  s_cmp_eq_u32 s45, 1
  s_cbranch_scc1 L_SETW
  v_and_b32 v2, 7, v0
  v_xor_b32 v2, v2, v1
  v_lshlrev_b32 v2, 4, v2
  v_lshrrev_b32 v3, 3, v0
  v_lshl_add_u32 v8, v3, 10, v2
  v_xor_b32 v9, 64, v8
  v_add_u32 v10, 14336, v8
  v_add_u32 v11, 21504, v9
  v_add_u32 v9, 7168, v9
  s_mov_b32 s48, 32768
  s_mov_b32 s49, 7
  s_mov_b32 s50, 0
  s_lshl_b32 s9, s5, 17
  s_waitcnt lgkmcnt(0)
  s_add_u32 s32, s16, s9
  s_addc_u32 s33, s17, 0
  s_and_b32 s33, s33, 0xffff
  s_sub_u32 s34, 1048576, s9
  s_mov_b32 s35, 0x20000
  s_branch L_CLGO
L_SETW:
  v_bfe_u32 v2, v0, 2, 2
  v_xor_b32 v2, v2, v1
  v_and_b32 v3, 3, v0
  v_lshlrev_b32 v3, 4, v3
  v_lshl_add_u32 v3, v2, 6, v3
  v_lshl_add_u32 v8, v1, 13, v3
  v_add_u32 v9, 31744, v8
  v_add_u32 v10, 63488, v8
  v_add_u32 v11, 95232, v8
  s_mov_b32 s48, 131072
  s_mov_b32 s49, 19
  s_mov_b32 s50, 16384
  s_lshl_b32 s9, s7, 8
  s_waitcnt lgkmcnt(0)
  s_add_u32 s32, s22, s9
  s_addc_u32 s33, s23, 0
  s_and_b32 s33, s33, 0xffff
  s_sub_u32 s34, 4194304, s9
  s_mov_b32 s35, 0x20000
L_CLGO:
  s_lshl_b32 s9, s45, 2
  v_add_u32 v12, s9, v31
  s_mov_b32 s40, 0
L_CL:
  s_cmp_ge_u32 s40, 8
  s_cbranch_scc1 L_CL_TAIL
  s_cmp_lt_u32 s40, 4
  s_cbranch_scc1 L_CL_ISS
  s_sub_u32 s11, s40, 3
WP_1:
  ds_read_b128 v[24:27], v31 offset:64
  s_waitcnt lgkmcnt(0)
  v_min_u32 v24, v24, v25
  v_min3_u32 v24, v24, v26, v27
  s_nop 0
  v_readfirstlane_b32 s12, v24
  s_cmp_ge_u32 s12, s11
  s_cbranch_scc1 WD_2
  s_sleep 1
  s_sub_u32 s14, s14, 1
  s_cbranch_scc1 L_ABORT
  s_branch WP_1
WD_2:
L_CL_ISS:
  s_add_u32 s42, s8, s40
  s_and_b32 s42, s42, 7
  s_lshl_b32 s9, s42, s49
  s_and_b32 s10, s40, 3
  s_lshl_b32 s10, s10, 15
  s_add_u32 s10, s10, s50
  s_mov_b32 m0, s10
  s_add_u32 s10, s10, 4096
  buffer_load_dwordx4 v8, s[32:35], s9 offen offset:0 lds
  buffer_load_dwordx4 v9, s[32:35], s9 offen offset:1024 lds
  buffer_load_dwordx4 v10, s[32:35], s9 offen offset:2048 lds
  buffer_load_dwordx4 v11, s[32:35], s9 offen offset:3072 lds
  s_add_u32 s9, s9, s48
  s_cmp_lt_u32 s40, 2
  s_cbranch_scc1 L_CL_B
  s_waitcnt vmcnt(20)
  v_subrev_u32 v13, 16, v12
  s_mov_b64 exec, 1
  ds_write_b32 v13, v30 offset:0
  s_mov_b64 exec, -1
L_CL_B:
  s_mov_b32 m0, s10
  s_add_u32 s10, s10, 4096
  buffer_load_dwordx4 v8, s[32:35], s9 offen offset:0 lds
  buffer_load_dwordx4 v9, s[32:35], s9 offen offset:1024 lds
  buffer_load_dwordx4 v10, s[32:35], s9 offen offset:2048 lds
  buffer_load_dwordx4 v11, s[32:35], s9 offen offset:3072 lds
  s_add_u32 s9, s9, s48
  s_mov_b32 m0, s10
  s_add_u32 s10, s10, 4096
  buffer_load_dwordx4 v8, s[32:35], s9 offen offset:0 lds
  buffer_load_dwordx4 v9, s[32:35], s9 offen offset:1024 lds
  buffer_load_dwordx4 v10, s[32:35], s9 offen offset:2048 lds
  buffer_load_dwordx4 v11, s[32:35], s9 offen offset:3072 lds
  s_add_u32 s9, s9, s48
  s_mov_b32 m0, s10
  s_add_u32 s10, s10, 4096
  buffer_load_dwordx4 v8, s[32:35], s9 offen offset:0 lds
  buffer_load_dwordx4 v9, s[32:35], s9 offen offset:1024 lds
  buffer_load_dwordx4 v10, s[32:35], s9 offen offset:2048 lds
  buffer_load_dwordx4 v11, s[32:35], s9 offen offset:3072 lds
  s_add_u32 s9, s9, s48
  s_cmp_lg_u32 s40, 0
  s_cbranch_scc1 L_CL_NOBAR
  s_barrier
L_CL_NOBAR:
  s_mov_b64 exec, 1
  ds_write_b32 v12, v30 offset:96
  s_mov_b64 exec, -1
  s_branch L_CL_NEXT
L_CL_TAIL:
  s_cmp_eq_u32 s40, 8
  s_cbranch_scc1 L_CL_W16
  s_waitcnt vmcnt(0)
L_CL_W16:
  s_waitcnt vmcnt(16)
  v_subrev_u32 v13, 16, v12
  s_mov_b64 exec, 1
  ds_write_b32 v13, v30 offset:0
  s_mov_b64 exec, -1
L_CL_NEXT:
  v_add_u32 v12, 8, v12
  s_add_u32 s40, s40, 1
  s_cmp_lt_u32 s40, 10
  s_cbranch_scc1 L_CL
  s_cmp_eq_u32 s45, 1
  s_cbranch_scc1 L_CL5
  s_mov_b32 s48, 0
  s_mov_b32 s49, 131072
  s_mov_b32 s50, 0
  s_mov_b32 s51, 2
  s_mov_b32 s52, 81920
  s_mov_b32 s53, 7
  s_mov_b32 s54, 0
  s_branch L_WO
L_CL5:
  s_mov_b32 s48, 1
  s_mov_b32 s49, 65536
  s_mov_b32 s50, 7
  s_mov_b32 s51, 3
  s_mov_b32 s52, 98304
  s_mov_b32 s53, 8
  s_mov_b32 s54, 0
  s_branch L_WO
L_OTHER:
  s_cmp_lg_u32 s3, 0
  s_cbranch_scc1 L_NOINIT
  v_lshl_add_u32 v2, v0, 2, v31
  v_mov_b32 v3, 0
  ds_write_b32 v2, v3
L_NOINIT:
  s_waitcnt lgkmcnt(0)
  s_barrier
  s_cmp_ge_u32 s3, 4
  s_cbranch_scc1 L_KV
L_COMPUTE:
  v_and_b32 v1, 31, v0
  v_lshrrev_b32 v2, 5, v0
  s_lshl_b32 s9, s3, 12
  v_bfe_u32 v7, v1, 1, 3
  v_xor_b32 v7, v7, v2
  v_lshlrev_b32 v7, 4, v7
  v_lshl_add_u32 v7, v1, 7, v7
  v_add_u32 v8, s9, v7
  v_xor_b32 v9, 32, v8
  v_xor_b32 v10, 64, v8
  v_xor_b32 v11, 96, v8
  v_bfe_u32 v3, v0, 2, 2
  v_bfe_u32 v5, v0, 4, 1
  v_and_b32 v24, 1, v0
  v_bfe_u32 v25, v0, 1, 1
  v_lshl_or_b32 v24, v24, 1, v25
  v_lshl_or_b32 v24, v5, 2, v24
  v_lshl_add_u32 v25, v2, 3, v3
  v_lshlrev_b32 v25, 8, v25
  v_lshl_add_u32 v25, v24, 3, v25
  v_add_u32 v25, 16384, v25
  v_xor_b32 v26, 0, v3
  v_lshl_add_u32 v12, v26, 6, v25
  v_xor_b32 v26, 1, v3
  v_lshl_add_u32 v13, v26, 6, v25
  v_xor_b32 v26, 2, v3
  v_lshl_add_u32 v14, v26, 6, v25
  v_xor_b32 v26, 3, v3
  v_lshl_add_u32 v15, v26, 6, v25
  v_add_u32 v16, 65536, v8
  v_add_u32 v20, 65536, v12
  v_add_u32 v17, 65536, v9
  v_add_u32 v21, 65536, v13
  v_add_u32 v18, 65536, v10
  v_add_u32 v22, 65536, v14
  v_add_u32 v19, 65536, v11
  v_add_u32 v23, 65536, v15
  v_lshrrev_b32 v3, 3, v0
  v_and_b32 v4, 7, v0
  v_xor_b32 v4, v4, v3
  v_lshlrev_b32 v4, 4, v4
  v_lshl_add_u32 v42, v3, 7, v4
  v_xor_b32 v43, 16, v42
  v_mov_b32 v64, 0
  v_mov_b32 v65, 0
  v_mov_b32 v66, 0
  v_mov_b32 v67, 0
  v_mov_b32 v68, 0
  v_mov_b32 v69, 0
  v_mov_b32 v70, 0
  v_mov_b32 v71, 0
  v_mov_b32 v72, 0
  v_mov_b32 v73, 0
  v_mov_b32 v74, 0
  v_mov_b32 v75, 0
  v_mov_b32 v76, 0
  v_mov_b32 v77, 0
  v_mov_b32 v78, 0
  v_mov_b32 v79, 0
  v_mov_b32 v80, 0
  v_mov_b32 v81, 0
  v_mov_b32 v82, 0
  v_mov_b32 v83, 0
  v_mov_b32 v84, 0
  v_mov_b32 v85, 0
  v_mov_b32 v86, 0
  v_mov_b32 v87, 0
  v_mov_b32 v88, 0
  v_mov_b32 v89, 0
  v_mov_b32 v90, 0
  v_mov_b32 v91, 0
  v_mov_b32 v92, 0
  v_mov_b32 v93, 0
  v_mov_b32 v94, 0
  v_mov_b32 v95, 0
  v_mov_b32 v96, 0
  v_mov_b32 v97, 0
  v_mov_b32 v98, 0
  v_mov_b32 v99, 0
  v_mov_b32 v100, 0
  v_mov_b32 v101, 0
  v_mov_b32 v102, 0
  v_mov_b32 v103, 0
  v_mov_b32 v104, 0
  v_mov_b32 v105, 0
  v_mov_b32 v106, 0
  v_mov_b32 v107, 0
  v_mov_b32 v108, 0
  v_mov_b32 v109, 0
  v_mov_b32 v110, 0
  v_mov_b32 v111, 0
  v_mov_b32 v112, 0
  v_mov_b32 v113, 0
  v_mov_b32 v114, 0
  v_mov_b32 v115, 0
  v_mov_b32 v116, 0
  v_mov_b32 v117, 0
  v_mov_b32 v118, 0
  v_mov_b32 v119, 0
  v_mov_b32 v120, 0
  v_mov_b32 v121, 0
  v_mov_b32 v122, 0
  v_mov_b32 v123, 0
  v_mov_b32 v124, 0
  v_mov_b32 v125, 0
  v_mov_b32 v126, 0
  v_mov_b32 v127, 0
  s_lshl_b32 s9, s3, 2
  s_add_u32 s9, s9, 162880
  v_mov_b32 v44, s9
  v_mov_b32 v45, 162816
  v_mov_b32 v46, 0
  s_lshr_b32 s9, s3, 1
  s_lshl_b32 s9, s9, 2
  v_add_u32 v47, s9, v31
  s_lshr_b32 s9, s3, 1
  s_lshl_b32 s9, s9, 14
  s_add_u32 s10, s9, 0
  s_add_u32 s11, s9, 32768
  v_and_b32 v24, 0x13, v1
  v_bfe_u32 v25, v1, 2, 1
  v_lshl_or_b32 v24, v25, 3, v24
  v_bfe_u32 v25, v1, 3, 1
  v_lshl_or_b32 v24, v25, 2, v24
  v_and_b32 v25, 15, v24
  v_xor_b32 v25, v25, v2
  v_lshlrev_b32 v25, 4, v25
  v_lshl_add_u32 v25, v24, 8, v25
  v_add_u32 v32, s10, v25
  v_xor_b32 v33, 32, v32
  v_xor_b32 v34, 64, v32
  v_xor_b32 v35, 96, v32
  v_xor_b32 v36, 128, v32
  v_xor_b32 v37, 160, v32
  v_xor_b32 v38, 192, v32
  v_xor_b32 v39, 224, v32
  v_add_u32 v40, s11, v42
  v_add_u32 v41, s11, v43
  s_mov_b32 s40, 0
  s_mov_b32 s43, 0x3e0293ee
  s_mov_b32 s44, 0xbe0293ee
  s_lshl_b32 s9, s5, 2
  s_add_u32 s9, s9, s3
  s_lshl_b32 s9, s9, 5
  s_lshl_b32 s10, s4, 3
  s_add_u32 s9, s9, s10
  s_lshl_b32 s9, s9, 13
  s_add_u32 s32, s30, s9
  s_addc_u32 s33, s31, 0
  s_and_b32 s33, s33, 0xffff
  s_sub_u32 s34, 8388608, s9
  s_mov_b32 s35, 0x20000
  s_mul_i32 s48, s15, 0
  s_add_u32 s48, s6, s48
  s_and_b32 s48, s48, 7
  s_lshl_b32 s48, s48, 13
  s_mul_i32 s49, s15, 1
  s_add_u32 s49, s6, s49
  s_and_b32 s49, s49, 7
  s_lshl_b32 s49, s49, 13
  s_mul_i32 s50, s15, 2
  s_add_u32 s50, s6, s50
  s_and_b32 s50, s50, 7
  s_lshl_b32 s50, s50, 13
  s_mul_i32 s51, s15, 3
  s_add_u32 s51, s6, s51
  s_and_b32 s51, s51, 7
  s_lshl_b32 s51, s51, 13
  s_mul_i32 s52, s15, 4
  s_add_u32 s52, s6, s52
  s_and_b32 s52, s52, 7
  s_lshl_b32 s52, s52, 13
  s_mul_i32 s53, s15, 5
  s_add_u32 s53, s6, s53
  s_and_b32 s53, s53, 7
  s_lshl_b32 s53, s53, 13
  s_mul_i32 s54, s15, 6
  s_add_u32 s54, s6, s54
  s_and_b32 s54, s54, 7
  s_lshl_b32 s54, s54, 13
  s_mul_i32 s55, s15, 7
  s_add_u32 s55, s6, s55
  s_and_b32 s55, s55, 7
  s_lshl_b32 s55, s55, 13
  s_lshl_b32 s9, s5, 2
  s_add_u32 s9, s9, s4
  s_lshl_b32 s9, s9, 2
  s_add_u32 s9, s9, s3
  s_lshl_b32 s9, s9, 8
  s_add_u32 s9, s9, 16777216
  s_add_u32 s36, s30, s9
  s_addc_u32 s37, s31, 0
  s_and_b32 s37, s37, 0xffff
  s_sub_u32 s38, 268435456, s9
  s_mov_b32 s39, 0x20000
  s_add_u32 s10, s30, s9
  s_addc_u32 s96, s31, 0
  v_lshlrev_b32 v3, 4, v0
  v_add_u32 v4, 4096, v3
  s_lshl_b32 s10, s6, 3
  v_mov_b32 v5, s10
  v_and_b32 v6, 7, v0
  v_lshlrev_b32 v6, 3, v6
  v_bfe_u32 v7, v0, 3, 1
  v_lshl_add_u32 v6, v7, 7, v6
WW_3:
  ds_read_b64 v[28:29], v31 offset:0
  s_waitcnt lgkmcnt(0)
  v_and_b32 v28, v28, v29
  s_nop 0
  v_readfirstlane_b32 s12, v28
  s_cmp_lg_u32 s12, 0
  s_cbranch_scc1 WD_4
  s_sleep 1
  s_sub_u32 s14, s14, 1
  s_cbranch_scc1 L_ABORT
  s_branch WW_3
WD_4:
  ds_read_b128 v[160:163], v8 offset:0
  ds_read_b64_tr_b16 v[128:129], v12 offset:0
  ds_read_b64_tr_b16 v[130:131], v12 offset:1024
  ds_read_b64_tr_b16 v[132:133], v13 offset:0
  ds_read_b64_tr_b16 v[134:135], v13 offset:1024
  ds_read_b64_tr_b16 v[136:137], v14 offset:0
  ds_read_b64_tr_b16 v[138:139], v14 offset:1024
  ds_read_b64_tr_b16 v[140:141], v15 offset:0
  ds_read_b64_tr_b16 v[142:143], v15 offset:1024
L_QLOOP:
L_QJ0:
  s_waitcnt lgkmcnt(4)
  v_mfma_f32_32x32x16_bf16 v[64:79], v[128:131], v[160:163], v[64:79]
  ds_read_b128 v[164:167], v9 offset:0
  ds_read_b64_tr_b16 v[144:145], v12 offset:4096
  ds_read_b64_tr_b16 v[146:147], v12 offset:5120
  v_mfma_f32_32x32x16_bf16 v[80:95], v[132:135], v[160:163], v[80:95]
  ds_read_b64_tr_b16 v[148:149], v13 offset:4096
  ds_read_b64_tr_b16 v[150:151], v13 offset:5120
  ds_read_b64_tr_b16 v[152:153], v14 offset:4096
  s_waitcnt lgkmcnt(6)
  v_mfma_f32_32x32x16_bf16 v[96:111], v[136:139], v[160:163], v[96:111]
  ds_read_b64_tr_b16 v[154:155], v14 offset:5120
  ds_read_b64_tr_b16 v[156:157], v15 offset:4096
  ds_read_b64_tr_b16 v[158:159], v15 offset:5120
  v_mfma_f32_32x32x16_bf16 v[112:127], v[140:143], v[160:163], v[112:127]
  s_waitcnt lgkmcnt(4)
  v_mfma_f32_32x32x16_bf16 v[64:79], v[144:147], v[164:167], v[64:79]
  ds_read_b128 v[160:163], v10 offset:0
  ds_read_b64_tr_b16 v[128:129], v12 offset:8192
  ds_read_b64_tr_b16 v[130:131], v12 offset:9216
  v_mfma_f32_32x32x16_bf16 v[80:95], v[148:151], v[164:167], v[80:95]
  ds_read_b64_tr_b16 v[132:133], v13 offset:8192
  ds_read_b64_tr_b16 v[134:135], v13 offset:9216
  ds_read_b64_tr_b16 v[136:137], v14 offset:8192
  s_waitcnt lgkmcnt(6)
  v_mfma_f32_32x32x16_bf16 v[96:111], v[152:155], v[164:167], v[96:111]
  ds_read_b64_tr_b16 v[138:139], v14 offset:9216
  ds_read_b64_tr_b16 v[140:141], v15 offset:8192
  ds_read_b64_tr_b16 v[142:143], v15 offset:9216
  ds_read_b64 v[28:29], v45 offset:8
  v_add_u32 v46, 1, v46
  v_mfma_f32_32x32x16_bf16 v[112:127], v[156:159], v[164:167], v[112:127]
  s_waitcnt lgkmcnt(5)
  v_mfma_f32_32x32x16_bf16 v[64:79], v[128:131], v[160:163], v[64:79]
  ds_read_b128 v[164:167], v11 offset:0
  ds_read_b64_tr_b16 v[144:145], v12 offset:12288
  ds_read_b64_tr_b16 v[146:147], v12 offset:13312
  v_mfma_f32_32x32x16_bf16 v[80:95], v[132:135], v[160:163], v[80:95]
  ds_read_b64_tr_b16 v[148:149], v13 offset:12288
  ds_read_b64_tr_b16 v[150:151], v13 offset:13312
  ds_read_b64_tr_b16 v[152:153], v14 offset:12288
  s_waitcnt lgkmcnt(6)
  v_mfma_f32_32x32x16_bf16 v[96:111], v[136:139], v[160:163], v[96:111]
  ds_read_b64_tr_b16 v[154:155], v14 offset:13312
  ds_read_b64_tr_b16 v[156:157], v15 offset:12288
  ds_read_b64_tr_b16 v[158:159], v15 offset:13312
  v_and_b32 v28, v28, v29
  s_mov_b64 exec, 1
  ds_write_b32 v44, v46
  s_mov_b64 exec, -1
  v_readfirstlane_b32 s12, v28
  s_cmp_lg_u32 s12, 0
  s_cbranch_scc1 QG_5
QS_6:
  ds_read_b64 v[28:29], v45 offset:8
  s_waitcnt lgkmcnt(0)
  v_and_b32 v28, v28, v29
  s_nop 0
  v_readfirstlane_b32 s12, v28
  s_cmp_lg_u32 s12, 0
  s_cbranch_scc1 QG_5
  s_sub_u32 s14, s14, 1
  s_cbranch_scc1 L_ABORT
  s_branch QS_6
QG_5:
  v_mfma_f32_32x32x16_bf16 v[112:127], v[140:143], v[160:163], v[112:127]
  s_waitcnt lgkmcnt(5)
  v_mfma_f32_32x32x16_bf16 v[64:79], v[144:147], v[164:167], v[64:79]
  ds_read_b128 v[160:163], v8 offset:32768
  ds_read_b64_tr_b16 v[128:129], v12 offset:32768
  ds_read_b64_tr_b16 v[130:131], v12 offset:33792
  v_mfma_f32_32x32x16_bf16 v[80:95], v[148:151], v[164:167], v[80:95]
  ds_read_b64_tr_b16 v[132:133], v13 offset:32768
  ds_read_b64_tr_b16 v[134:135], v13 offset:33792
  ds_read_b64_tr_b16 v[136:137], v14 offset:32768
  s_waitcnt lgkmcnt(7)
  v_mfma_f32_32x32x16_bf16 v[96:111], v[152:155], v[164:167], v[96:111]
  ds_read_b64_tr_b16 v[138:139], v14 offset:33792
  ds_read_b64_tr_b16 v[140:141], v15 offset:32768
  ds_read_b64_tr_b16 v[142:143], v15 offset:33792
  v_mfma_f32_32x32x16_bf16 v[112:127], v[156:159], v[164:167], v[112:127]
L_QJ1:
  s_waitcnt lgkmcnt(4)
  v_mfma_f32_32x32x16_bf16 v[64:79], v[128:131], v[160:163], v[64:79]
  ds_read_b128 v[164:167], v9 offset:32768
  ds_read_b64_tr_b16 v[144:145], v12 offset:36864
  ds_read_b64_tr_b16 v[146:147], v12 offset:37888
  v_mfma_f32_32x32x16_bf16 v[80:95], v[132:135], v[160:163], v[80:95]
  ds_read_b64_tr_b16 v[148:149], v13 offset:36864
  ds_read_b64_tr_b16 v[150:151], v13 offset:37888
  ds_read_b64_tr_b16 v[152:153], v14 offset:36864
  s_waitcnt lgkmcnt(6)
  v_mfma_f32_32x32x16_bf16 v[96:111], v[136:139], v[160:163], v[96:111]
  ds_read_b64_tr_b16 v[154:155], v14 offset:37888
  ds_read_b64_tr_b16 v[156:157], v15 offset:36864
  ds_read_b64_tr_b16 v[158:159], v15 offset:37888
  v_mfma_f32_32x32x16_bf16 v[112:127], v[140:143], v[160:163], v[112:127]
  s_waitcnt lgkmcnt(4)
  v_mfma_f32_32x32x16_bf16 v[64:79], v[144:147], v[164:167], v[64:79]
  ds_read_b128 v[160:163], v10 offset:32768
  ds_read_b64_tr_b16 v[128:129], v12 offset:40960
  ds_read_b64_tr_b16 v[130:131], v12 offset:41984
  v_mfma_f32_32x32x16_bf16 v[80:95], v[148:151], v[164:167], v[80:95]
  ds_read_b64_tr_b16 v[132:133], v13 offset:40960
  ds_read_b64_tr_b16 v[134:135], v13 offset:41984
  ds_read_b64_tr_b16 v[136:137], v14 offset:40960
  s_waitcnt lgkmcnt(6)
  v_mfma_f32_32x32x16_bf16 v[96:111], v[152:155], v[164:167], v[96:111]
  ds_read_b64_tr_b16 v[138:139], v14 offset:41984
  ds_read_b64_tr_b16 v[140:141], v15 offset:40960
  ds_read_b64_tr_b16 v[142:143], v15 offset:41984
  ds_read_b64 v[28:29], v45 offset:16
  v_add_u32 v46, 1, v46
  v_mfma_f32_32x32x16_bf16 v[112:127], v[156:159], v[164:167], v[112:127]
  s_waitcnt lgkmcnt(5)
  v_mfma_f32_32x32x16_bf16 v[64:79], v[128:131], v[160:163], v[64:79]
  ds_read_b128 v[164:167], v11 offset:32768
  ds_read_b64_tr_b16 v[144:145], v12 offset:45056
  ds_read_b64_tr_b16 v[146:147], v12 offset:46080
  v_mfma_f32_32x32x16_bf16 v[80:95], v[132:135], v[160:163], v[80:95]
  ds_read_b64_tr_b16 v[148:149], v13 offset:45056
  ds_read_b64_tr_b16 v[150:151], v13 offset:46080
  ds_read_b64_tr_b16 v[152:153], v14 offset:45056
  s_waitcnt lgkmcnt(6)
  v_mfma_f32_32x32x16_bf16 v[96:111], v[136:139], v[160:163], v[96:111]
  ds_read_b64_tr_b16 v[154:155], v14 offset:46080
  ds_read_b64_tr_b16 v[156:157], v15 offset:45056
  ds_read_b64_tr_b16 v[158:159], v15 offset:46080
  v_and_b32 v28, v28, v29
  s_mov_b64 exec, 1
  ds_write_b32 v44, v46
  s_mov_b64 exec, -1
  v_readfirstlane_b32 s12, v28
  s_cmp_lg_u32 s12, 0
  s_cbranch_scc1 QG_7
QS_8:
  ds_read_b64 v[28:29], v45 offset:16
  s_waitcnt lgkmcnt(0)
  v_and_b32 v28, v28, v29
  s_nop 0
  v_readfirstlane_b32 s12, v28
  s_cmp_lg_u32 s12, 0
  s_cbranch_scc1 QG_7
  s_sub_u32 s14, s14, 1
  s_cbranch_scc1 L_ABORT
  s_branch QS_8
QG_7:
  v_mfma_f32_32x32x16_bf16 v[112:127], v[140:143], v[160:163], v[112:127]
  s_waitcnt lgkmcnt(5)
  v_mfma_f32_32x32x16_bf16 v[64:79], v[144:147], v[164:167], v[64:79]
  ds_read_b128 v[160:163], v16 offset:0
  ds_read_b64_tr_b16 v[128:129], v20 offset:0
  ds_read_b64_tr_b16 v[130:131], v20 offset:1024
  v_mfma_f32_32x32x16_bf16 v[80:95], v[148:151], v[164:167], v[80:95]
  ds_read_b64_tr_b16 v[132:133], v21 offset:0
  ds_read_b64_tr_b16 v[134:135], v21 offset:1024
  ds_read_b64_tr_b16 v[136:137], v22 offset:0
  s_waitcnt lgkmcnt(7)
  v_mfma_f32_32x32x16_bf16 v[96:111], v[152:155], v[164:167], v[96:111]
  ds_read_b64_tr_b16 v[138:139], v22 offset:1024
  ds_read_b64_tr_b16 v[140:141], v23 offset:0
  ds_read_b64_tr_b16 v[142:143], v23 offset:1024
  v_mfma_f32_32x32x16_bf16 v[112:127], v[156:159], v[164:167], v[112:127]
L_QJ2:
  s_waitcnt lgkmcnt(4)
  v_mfma_f32_32x32x16_bf16 v[64:79], v[128:131], v[160:163], v[64:79]
  ds_read_b128 v[164:167], v17 offset:0
  ds_read_b64_tr_b16 v[144:145], v20 offset:4096
  ds_read_b64_tr_b16 v[146:147], v20 offset:5120
  v_mfma_f32_32x32x16_bf16 v[80:95], v[132:135], v[160:163], v[80:95]
  ds_read_b64_tr_b16 v[148:149], v21 offset:4096
  ds_read_b64_tr_b16 v[150:151], v21 offset:5120
  ds_read_b64_tr_b16 v[152:153], v22 offset:4096
  s_waitcnt lgkmcnt(6)
  v_mfma_f32_32x32x16_bf16 v[96:111], v[136:139], v[160:163], v[96:111]
  ds_read_b64_tr_b16 v[154:155], v22 offset:5120
  ds_read_b64_tr_b16 v[156:157], v23 offset:4096
  ds_read_b64_tr_b16 v[158:159], v23 offset:5120
  v_mfma_f32_32x32x16_bf16 v[112:127], v[140:143], v[160:163], v[112:127]
  s_waitcnt lgkmcnt(4)
  v_mfma_f32_32x32x16_bf16 v[64:79], v[144:147], v[164:167], v[64:79]
  ds_read_b128 v[160:163], v18 offset:0
  ds_read_b64_tr_b16 v[128:129], v20 offset:8192
  ds_read_b64_tr_b16 v[130:131], v20 offset:9216
  v_mfma_f32_32x32x16_bf16 v[80:95], v[148:151], v[164:167], v[80:95]
  ds_read_b64_tr_b16 v[132:133], v21 offset:8192
  ds_read_b64_tr_b16 v[134:135], v21 offset:9216
  ds_read_b64_tr_b16 v[136:137], v22 offset:8192
  s_waitcnt lgkmcnt(6)
  v_mfma_f32_32x32x16_bf16 v[96:111], v[152:155], v[164:167], v[96:111]
  ds_read_b64_tr_b16 v[138:139], v22 offset:9216
  ds_read_b64_tr_b16 v[140:141], v23 offset:8192
  ds_read_b64_tr_b16 v[142:143], v23 offset:9216
  ds_read_b64 v[28:29], v45 offset:24
  v_add_u32 v46, 1, v46
  v_mfma_f32_32x32x16_bf16 v[112:127], v[156:159], v[164:167], v[112:127]
  s_waitcnt lgkmcnt(5)
  v_mfma_f32_32x32x16_bf16 v[64:79], v[128:131], v[160:163], v[64:79]
  ds_read_b128 v[164:167], v19 offset:0
  ds_read_b64_tr_b16 v[144:145], v20 offset:12288
  ds_read_b64_tr_b16 v[146:147], v20 offset:13312
  v_mfma_f32_32x32x16_bf16 v[80:95], v[132:135], v[160:163], v[80:95]
  ds_read_b64_tr_b16 v[148:149], v21 offset:12288
  ds_read_b64_tr_b16 v[150:151], v21 offset:13312
  ds_read_b64_tr_b16 v[152:153], v22 offset:12288
  s_waitcnt lgkmcnt(6)
  v_mfma_f32_32x32x16_bf16 v[96:111], v[136:139], v[160:163], v[96:111]
  ds_read_b64_tr_b16 v[154:155], v22 offset:13312
  ds_read_b64_tr_b16 v[156:157], v23 offset:12288
  ds_read_b64_tr_b16 v[158:159], v23 offset:13312
  v_and_b32 v28, v28, v29
  s_mov_b64 exec, 1
  ds_write_b32 v44, v46
  s_mov_b64 exec, -1
  v_readfirstlane_b32 s12, v28
  s_cmp_lg_u32 s12, 0
  s_cbranch_scc1 QG_9
QS_10:
  ds_read_b64 v[28:29], v45 offset:24
  s_waitcnt lgkmcnt(0)
  v_and_b32 v28, v28, v29
  s_nop 0
  v_readfirstlane_b32 s12, v28
  s_cmp_lg_u32 s12, 0
  s_cbranch_scc1 QG_9
  s_sub_u32 s14, s14, 1
  s_cbranch_scc1 L_ABORT
  s_branch QS_10
QG_9:
  v_mfma_f32_32x32x16_bf16 v[112:127], v[140:143], v[160:163], v[112:127]
  s_waitcnt lgkmcnt(5)
  v_mfma_f32_32x32x16_bf16 v[64:79], v[144:147], v[164:167], v[64:79]
  ds_read_b128 v[160:163], v16 offset:32768
  ds_read_b64_tr_b16 v[128:129], v20 offset:32768
  ds_read_b64_tr_b16 v[130:131], v20 offset:33792
  v_mfma_f32_32x32x16_bf16 v[80:95], v[148:151], v[164:167], v[80:95]
  ds_read_b64_tr_b16 v[132:133], v21 offset:32768
  ds_read_b64_tr_b16 v[134:135], v21 offset:33792
  ds_read_b64_tr_b16 v[136:137], v22 offset:32768
  s_waitcnt lgkmcnt(7)
  v_mfma_f32_32x32x16_bf16 v[96:111], v[152:155], v[164:167], v[96:111]
  ds_read_b64_tr_b16 v[138:139], v22 offset:33792
  ds_read_b64_tr_b16 v[140:141], v23 offset:32768
  ds_read_b64_tr_b16 v[142:143], v23 offset:33792
  v_mfma_f32_32x32x16_bf16 v[112:127], v[156:159], v[164:167], v[112:127]
L_QJ3:
  s_waitcnt lgkmcnt(4)
  v_mfma_f32_32x32x16_bf16 v[64:79], v[128:131], v[160:163], v[64:79]
  ds_read_b128 v[164:167], v17 offset:32768
  ds_read_b64_tr_b16 v[144:145], v20 offset:36864
  ds_read_b64_tr_b16 v[146:147], v20 offset:37888
  v_mfma_f32_32x32x16_bf16 v[80:95], v[132:135], v[160:163], v[80:95]
  ds_read_b64_tr_b16 v[148:149], v21 offset:36864
  ds_read_b64_tr_b16 v[150:151], v21 offset:37888
  ds_read_b64_tr_b16 v[152:153], v22 offset:36864
  s_waitcnt lgkmcnt(6)
  v_mfma_f32_32x32x16_bf16 v[96:111], v[136:139], v[160:163], v[96:111]
  ds_read_b64_tr_b16 v[154:155], v22 offset:37888
  ds_read_b64_tr_b16 v[156:157], v23 offset:36864
  ds_read_b64_tr_b16 v[158:159], v23 offset:37888
  v_mfma_f32_32x32x16_bf16 v[112:127], v[140:143], v[160:163], v[112:127]
  s_waitcnt lgkmcnt(4)
  v_mfma_f32_32x32x16_bf16 v[64:79], v[144:147], v[164:167], v[64:79]
  ds_read_b128 v[160:163], v18 offset:32768
  ds_read_b64_tr_b16 v[128:129], v20 offset:40960
  ds_read_b64_tr_b16 v[130:131], v20 offset:41984
  v_mfma_f32_32x32x16_bf16 v[80:95], v[148:151], v[164:167], v[80:95]
  ds_read_b64_tr_b16 v[132:133], v21 offset:40960
  ds_read_b64_tr_b16 v[134:135], v21 offset:41984
  ds_read_b64_tr_b16 v[136:137], v22 offset:40960
  s_waitcnt lgkmcnt(6)
  v_mfma_f32_32x32x16_bf16 v[96:111], v[152:155], v[164:167], v[96:111]
  ds_read_b64_tr_b16 v[138:139], v22 offset:41984
  ds_read_b64_tr_b16 v[140:141], v23 offset:40960
  ds_read_b64_tr_b16 v[142:143], v23 offset:41984
  ds_read_b64 v[28:29], v45 offset:32
  v_add_u32 v46, 1, v46
  v_mfma_f32_32x32x16_bf16 v[112:127], v[156:159], v[164:167], v[112:127]
  s_waitcnt lgkmcnt(5)
  v_mfma_f32_32x32x16_bf16 v[64:79], v[128:131], v[160:163], v[64:79]
  ds_read_b128 v[164:167], v19 offset:32768
  ds_read_b64_tr_b16 v[144:145], v20 offset:45056
  ds_read_b64_tr_b16 v[146:147], v20 offset:46080
  v_mfma_f32_32x32x16_bf16 v[80:95], v[132:135], v[160:163], v[80:95]
  ds_read_b64_tr_b16 v[148:149], v21 offset:45056
  ds_read_b64_tr_b16 v[150:151], v21 offset:46080
  ds_read_b64_tr_b16 v[152:153], v22 offset:45056
  s_waitcnt lgkmcnt(6)
  v_mfma_f32_32x32x16_bf16 v[96:111], v[136:139], v[160:163], v[96:111]
  ds_read_b64_tr_b16 v[154:155], v22 offset:46080
  ds_read_b64_tr_b16 v[156:157], v23 offset:45056
  ds_read_b64_tr_b16 v[158:159], v23 offset:46080
  v_and_b32 v28, v28, v29
  s_mov_b64 exec, 1
  ds_write_b32 v44, v46
  s_mov_b64 exec, -1
  v_readfirstlane_b32 s12, v28
  s_cmp_eq_u32 s40, 1
  s_cbranch_scc1 L_QTAIL
  s_cmp_lg_u32 s12, 0
  s_cbranch_scc1 QG_11
QS_12:
  ds_read_b64 v[28:29], v45 offset:32
  s_waitcnt lgkmcnt(0)
  v_and_b32 v28, v28, v29
  s_nop 0
  v_readfirstlane_b32 s12, v28
  s_cmp_lg_u32 s12, 0
  s_cbranch_scc1 QG_11
  s_sub_u32 s14, s14, 1
  s_cbranch_scc1 L_ABORT
  s_branch QS_12
QG_11:
  v_mfma_f32_32x32x16_bf16 v[112:127], v[140:143], v[160:163], v[112:127]
  s_waitcnt lgkmcnt(5)
  v_mfma_f32_32x32x16_bf16 v[64:79], v[144:147], v[164:167], v[64:79]
  ds_read_b128 v[160:163], v8 offset:0
  ds_read_b64_tr_b16 v[128:129], v12 offset:0
  ds_read_b64_tr_b16 v[130:131], v12 offset:1024
  v_mfma_f32_32x32x16_bf16 v[80:95], v[148:151], v[164:167], v[80:95]
  ds_read_b64_tr_b16 v[132:133], v13 offset:0
  ds_read_b64_tr_b16 v[134:135], v13 offset:1024
  ds_read_b64_tr_b16 v[136:137], v14 offset:0
  s_waitcnt lgkmcnt(7)
  v_mfma_f32_32x32x16_bf16 v[96:111], v[152:155], v[164:167], v[96:111]
  ds_read_b64_tr_b16 v[138:139], v14 offset:1024
  ds_read_b64_tr_b16 v[140:141], v15 offset:0
  ds_read_b64_tr_b16 v[142:143], v15 offset:1024
  v_mfma_f32_32x32x16_bf16 v[112:127], v[156:159], v[164:167], v[112:127]
L_QJ4:
  v_add_u32 v45, 32, v45
  s_mov_b32 s40, 1
  s_branch L_QLOOP
L_QTAIL:
  v_mfma_f32_32x32x16_bf16 v[112:127], v[140:143], v[160:163], v[112:127]
  ds_read_b32 v28, v47 offset:80
  s_waitcnt lgkmcnt(6)
  v_mfma_f32_32x32x16_bf16 v[64:79], v[144:147], v[164:167], v[64:79]
  v_mfma_f32_32x32x16_bf16 v[80:95], v[148:151], v[164:167], v[80:95]
  s_waitcnt lgkmcnt(0)
  v_mfma_f32_32x32x16_bf16 v[96:111], v[152:155], v[164:167], v[96:111]
  v_readfirstlane_b32 s12, v28
  v_mfma_f32_32x32x16_bf16 v[112:127], v[156:159], v[164:167], v[112:127]
  s_cmp_lg_u32 s12, 0
  s_cbranch_scc1 L_KOK
WW_13:
  ds_read_b32 v28, v47 offset:80
  s_waitcnt lgkmcnt(0)
  v_readfirstlane_b32 s12, v28
  s_cmp_lg_u32 s12, 0
  s_cbranch_scc1 WD_14
  s_sub_u32 s14, s14, 1
  s_cbranch_scc1 L_ABORT
  s_branch WW_13
WD_14:
L_KOK:
  ds_read_b128 v[232:235], v32 offset:0
  ds_read_b128 v[236:239], v32 offset:8192
  ds_read_b128 v[240:243], v33 offset:0
  ds_read_b128 v[244:247], v33 offset:8192
  ds_read_b128 v[128:131], v34 offset:0
  ds_read_b128 v[132:135], v34 offset:8192
  ds_read_b128 v[136:139], v35 offset:0
  ds_read_b128 v[140:143], v35 offset:8192
  ds_read_b128 v[144:147], v36 offset:0
  ds_read_b128 v[148:151], v36 offset:8192
  ds_read_b128 v[152:155], v37 offset:0
  ds_read_b128 v[156:159], v37 offset:8192
  v_cvt_pk_bf16_f32 v168, v64, v65
  v_cvt_pk_bf16_f32 v169, v66, v67
  v_cvt_pk_bf16_f32 v170, v68, v69
  v_cvt_pk_bf16_f32 v171, v70, v71
  v_cvt_pk_bf16_f32 v172, v72, v73
  v_cvt_pk_bf16_f32 v173, v74, v75
  v_cvt_pk_bf16_f32 v174, v76, v77
  v_cvt_pk_bf16_f32 v175, v78, v79
  s_waitcnt lgkmcnt(11)
  v_mfma_f32_32x32x16_bf16 v[200:215], v[232:235], v[168:171], 0
  v_cvt_pk_bf16_f32 v176, v80, v81
  v_cvt_pk_bf16_f32 v177, v82, v83
  v_cvt_pk_bf16_f32 v178, v84, v85
  v_cvt_pk_bf16_f32 v179, v86, v87
  s_waitcnt lgkmcnt(10)
  v_mfma_f32_32x32x16_bf16 v[216:231], v[236:239], v[168:171], 0
  s_waitcnt lgkmcnt(9)
  v_mfma_f32_32x32x16_bf16 v[200:215], v[240:243], v[172:175], v[200:215]
  v_cvt_pk_bf16_f32 v180, v88, v89
  v_cvt_pk_bf16_f32 v181, v90, v91
  v_cvt_pk_bf16_f32 v182, v92, v93
  v_cvt_pk_bf16_f32 v183, v94, v95
  s_waitcnt lgkmcnt(8)
  v_mfma_f32_32x32x16_bf16 v[216:231], v[244:247], v[172:175], v[216:231]
  s_waitcnt lgkmcnt(7)
  v_mfma_f32_32x32x16_bf16 v[200:215], v[128:131], v[176:179], v[200:215]
  ds_read_b128 v[128:131], v38 offset:0
  v_cvt_pk_bf16_f32 v184, v96, v97
  v_cvt_pk_bf16_f32 v185, v98, v99
  v_cvt_pk_bf16_f32 v186, v100, v101
  v_cvt_pk_bf16_f32 v187, v102, v103
  s_waitcnt lgkmcnt(7)
  v_mfma_f32_32x32x16_bf16 v[216:231], v[132:135], v[176:179], v[216:231]
  ds_read_b128 v[132:135], v38 offset:8192
  s_waitcnt lgkmcnt(7)
  v_mfma_f32_32x32x16_bf16 v[200:215], v[136:139], v[180:183], v[200:215]
  ds_read_b128 v[136:139], v39 offset:0
  v_cvt_pk_bf16_f32 v188, v104, v105
  v_cvt_pk_bf16_f32 v189, v106, v107
  v_cvt_pk_bf16_f32 v190, v108, v109
  v_cvt_pk_bf16_f32 v191, v110, v111
  s_waitcnt lgkmcnt(7)
  v_mfma_f32_32x32x16_bf16 v[216:231], v[140:143], v[180:183], v[216:231]
  ds_read_b128 v[140:143], v39 offset:8192
  v_mov_b32 v46, 9
  s_mov_b64 exec, 1
  ds_write_b32 v44, v46
  s_mov_b64 exec, -1
  ds_read_b32 v28, v47 offset:88
  s_waitcnt lgkmcnt(7)
  v_mfma_f32_32x32x16_bf16 v[200:215], v[144:147], v[184:187], v[200:215]
  v_cvt_pk_bf16_f32 v192, v112, v113
  v_cvt_pk_bf16_f32 v193, v114, v115
  v_cvt_pk_bf16_f32 v194, v116, v117
  v_cvt_pk_bf16_f32 v195, v118, v119
  s_waitcnt lgkmcnt(6)
  v_mfma_f32_32x32x16_bf16 v[216:231], v[148:151], v[184:187], v[216:231]
  s_waitcnt lgkmcnt(5)
  v_mfma_f32_32x32x16_bf16 v[200:215], v[152:155], v[188:191], v[200:215]
  v_cvt_pk_bf16_f32 v196, v120, v121
  v_cvt_pk_bf16_f32 v197, v122, v123
  v_cvt_pk_bf16_f32 v198, v124, v125
  v_cvt_pk_bf16_f32 v199, v126, v127
  s_waitcnt lgkmcnt(4)
  v_mfma_f32_32x32x16_bf16 v[216:231], v[156:159], v[188:191], v[216:231]
  s_waitcnt lgkmcnt(3)
  v_mfma_f32_32x32x16_bf16 v[200:215], v[128:131], v[192:195], v[200:215]
  s_waitcnt lgkmcnt(2)
  v_mfma_f32_32x32x16_bf16 v[216:231], v[132:135], v[192:195], v[216:231]
  s_waitcnt lgkmcnt(1)
  v_mfma_f32_32x32x16_bf16 v[200:215], v[136:139], v[196:199], v[200:215]
  s_waitcnt lgkmcnt(0)
  v_mfma_f32_32x32x16_bf16 v[216:231], v[140:143], v[196:199], v[216:231]
  v_readfirstlane_b32 s12, v28
  s_cmp_lg_u32 s12, 0
  s_cbranch_scc1 L_VOK1
  s_mov_b32 s11, 0
  s_branch L_VOK2
L_VOK1:
  ds_read_b128 v[128:131], v40 offset:0
  ds_read_b128 v[132:135], v41 offset:1024
  ds_read_b128 v[136:139], v40 offset:2048
  ds_read_b128 v[140:143], v41 offset:3072
  ds_read_b128 v[144:147], v40 offset:4096
  ds_read_b128 v[148:151], v41 offset:5120
  ds_read_b128 v[152:155], v40 offset:6144
  ds_read_b128 v[156:159], v41 offset:7168
  s_mov_b32 s11, 1
L_VOK2:
  s_nop 7
  v_max3_f32 v24, v200, v201, v202
  v_max3_f32 v25, v203, v204, v205
  v_max3_f32 v24, v24, v206, v207
  v_max3_f32 v25, v25, v208, v209
  v_max3_f32 v24, v24, v210, v211
  v_max3_f32 v25, v25, v212, v213
  v_max3_f32 v24, v24, v214, v215
  v_max3_f32 v25, v25, v216, v217
  v_max3_f32 v24, v24, v218, v219
  v_max3_f32 v25, v25, v220, v221
  v_max3_f32 v24, v24, v222, v223
  v_max3_f32 v25, v25, v224, v225
  v_max3_f32 v24, v24, v226, v227
  v_max3_f32 v25, v25, v228, v229
  v_max3_f32 v24, v24, v230, v231
  v_max_f32 v24, v24, v25
  v_mov_b32 v25, v24
  s_nop 1
  v_permlane32_swap_b32 v25, v24
  s_nop 1
  v_max_f32 v24, v24, v25
  v_mul_f32 v24, s44, v24
  v_fma_f32 v200, v200, s43, v24
  v_fma_f32 v201, v201, s43, v24
  v_fma_f32 v202, v202, s43, v24
  v_fma_f32 v203, v203, s43, v24
  v_fma_f32 v204, v204, s43, v24
  v_fma_f32 v205, v205, s43, v24
  v_fma_f32 v206, v206, s43, v24
  v_fma_f32 v207, v207, s43, v24
  v_exp_f32 v200, v200
  v_exp_f32 v201, v201
  v_exp_f32 v202, v202
  v_exp_f32 v203, v203
  v_exp_f32 v204, v204
  v_exp_f32 v205, v205
  v_exp_f32 v206, v206
  v_exp_f32 v207, v207
  v_cvt_pk_bf16_f32 v232, v200, v201
  v_cvt_pk_bf16_f32 v233, v202, v203
  v_cvt_pk_bf16_f32 v234, v204, v205
  v_cvt_pk_bf16_f32 v235, v206, v207
  s_cmp_eq_u32 s11, 1
  s_cbranch_scc1 L_VOK3
WW_15:
  ds_read_b32 v28, v47 offset:88
  s_waitcnt lgkmcnt(0)
  v_readfirstlane_b32 s12, v28
  s_cmp_lg_u32 s12, 0
  s_cbranch_scc1 WD_16
  s_sub_u32 s14, s14, 1
  s_cbranch_scc1 L_ABORT
  s_branch WW_15
WD_16:
  ds_read_b128 v[128:131], v40 offset:0
  ds_read_b128 v[132:135], v41 offset:1024
  ds_read_b128 v[136:139], v40 offset:2048
  ds_read_b128 v[140:143], v41 offset:3072
  ds_read_b128 v[144:147], v40 offset:4096
  ds_read_b128 v[148:151], v41 offset:5120
  ds_read_b128 v[152:155], v40 offset:6144
  ds_read_b128 v[156:159], v41 offset:7168
L_VOK3:
  s_waitcnt lgkmcnt(7)
  v_mfma_f32_32x32x16_bf16 v[64:79], v[128:131], v[232:235], 0
  ds_read_b128 v[128:131], v40 offset:8192
  v_fma_f32 v208, v208, s43, v24
  v_fma_f32 v209, v209, s43, v24
  v_fma_f32 v210, v210, s43, v24
  v_fma_f32 v211, v211, s43, v24
  v_fma_f32 v212, v212, s43, v24
  v_fma_f32 v213, v213, s43, v24
  v_fma_f32 v214, v214, s43, v24
  s_waitcnt lgkmcnt(7)
  v_mfma_f32_32x32x16_bf16 v[80:95], v[132:135], v[232:235], 0
  ds_read_b128 v[132:135], v41 offset:9216
  v_fma_f32 v215, v215, s43, v24
  v_exp_f32 v208, v208
  v_exp_f32 v209, v209
  v_exp_f32 v210, v210
  v_exp_f32 v211, v211
  v_exp_f32 v212, v212
  v_exp_f32 v213, v213
  s_waitcnt lgkmcnt(7)
  v_mfma_f32_32x32x16_bf16 v[96:111], v[136:139], v[232:235], 0
  ds_read_b128 v[136:139], v40 offset:10240
  v_exp_f32 v214, v214
  v_exp_f32 v215, v215
  v_cvt_pk_bf16_f32 v236, v208, v209
  v_cvt_pk_bf16_f32 v237, v210, v211
  v_cvt_pk_bf16_f32 v238, v212, v213
  v_cvt_pk_bf16_f32 v239, v214, v215
  v_mov_b32 v25, v200
  s_waitcnt lgkmcnt(7)
  v_mfma_f32_32x32x16_bf16 v[112:127], v[140:143], v[232:235], 0
  ds_read_b128 v[140:143], v41 offset:11264
  v_mov_b32 v26, v201
  v_add_f32 v25, v25, v202
  v_add_f32 v26, v26, v203
  v_add_f32 v25, v25, v204
  v_add_f32 v26, v26, v205
  v_add_f32 v25, v25, v206
  v_add_f32 v26, v26, v207
  s_waitcnt lgkmcnt(7)
  v_mfma_f32_32x32x16_bf16 v[64:79], v[144:147], v[236:239], v[64:79]
  ds_read_b128 v[144:147], v40 offset:12288
  v_fma_f32 v216, v216, s43, v24
  v_fma_f32 v217, v217, s43, v24
  v_fma_f32 v218, v218, s43, v24
  v_fma_f32 v219, v219, s43, v24
  v_fma_f32 v220, v220, s43, v24
  v_fma_f32 v221, v221, s43, v24
  v_fma_f32 v222, v222, s43, v24
  s_waitcnt lgkmcnt(7)
  v_mfma_f32_32x32x16_bf16 v[80:95], v[148:151], v[236:239], v[80:95]
  ds_read_b128 v[148:151], v41 offset:13312
  v_fma_f32 v223, v223, s43, v24
  v_exp_f32 v216, v216
  v_exp_f32 v217, v217
  v_exp_f32 v218, v218
  v_exp_f32 v219, v219
  v_exp_f32 v220, v220
  v_exp_f32 v221, v221
  s_waitcnt lgkmcnt(7)
  v_mfma_f32_32x32x16_bf16 v[96:111], v[152:155], v[236:239], v[96:111]
  ds_read_b128 v[152:155], v40 offset:14336
  v_exp_f32 v222, v222
  v_exp_f32 v223, v223
  v_cvt_pk_bf16_f32 v240, v216, v217
  v_cvt_pk_bf16_f32 v241, v218, v219
  v_cvt_pk_bf16_f32 v242, v220, v221
  v_cvt_pk_bf16_f32 v243, v222, v223
  v_add_f32 v25, v25, v208
  s_waitcnt lgkmcnt(7)
  v_mfma_f32_32x32x16_bf16 v[112:127], v[156:159], v[236:239], v[112:127]
  ds_read_b128 v[156:159], v41 offset:15360
  v_mov_b32 v46, 10
  s_mov_b64 exec, 1
  ds_write_b32 v44, v46
  s_mov_b64 exec, -1
  ds_read_b64 v[16:17], v31 offset:192
  v_add_f32 v26, v26, v209
  v_add_f32 v25, v25, v210
  v_add_f32 v26, v26, v211
  v_add_f32 v25, v25, v212
  v_add_f32 v26, v26, v213
  v_add_f32 v25, v25, v214
  v_add_f32 v26, v26, v215
  s_waitcnt lgkmcnt(9)
  v_mfma_f32_32x32x16_bf16 v[64:79], v[128:131], v[240:243], v[64:79]
  v_fma_f32 v224, v224, s43, v24
  v_fma_f32 v225, v225, s43, v24
  v_fma_f32 v226, v226, s43, v24
  v_fma_f32 v227, v227, s43, v24
  v_fma_f32 v228, v228, s43, v24
  v_fma_f32 v229, v229, s43, v24
  v_fma_f32 v230, v230, s43, v24
  s_waitcnt lgkmcnt(8)
  v_mfma_f32_32x32x16_bf16 v[80:95], v[132:135], v[240:243], v[80:95]
  v_fma_f32 v231, v231, s43, v24
  v_exp_f32 v224, v224
  v_exp_f32 v225, v225
  v_exp_f32 v226, v226
  v_exp_f32 v227, v227
  v_exp_f32 v228, v228
  v_exp_f32 v229, v229
  s_waitcnt lgkmcnt(7)
  v_mfma_f32_32x32x16_bf16 v[96:111], v[136:139], v[240:243], v[96:111]
  v_exp_f32 v230, v230
  v_exp_f32 v231, v231
  v_cvt_pk_bf16_f32 v244, v224, v225
  v_cvt_pk_bf16_f32 v245, v226, v227
  v_cvt_pk_bf16_f32 v246, v228, v229
  v_cvt_pk_bf16_f32 v247, v230, v231
  v_add_f32 v25, v25, v216
  s_waitcnt lgkmcnt(6)
  v_mfma_f32_32x32x16_bf16 v[112:127], v[140:143], v[240:243], v[112:127]
  v_add_f32 v26, v26, v217
  v_add_f32 v25, v25, v218
  v_add_f32 v26, v26, v219
  v_add_f32 v25, v25, v220
  v_add_f32 v26, v26, v221
  v_add_f32 v25, v25, v222
  v_add_f32 v26, v26, v223
  s_waitcnt lgkmcnt(5)
  v_mfma_f32_32x32x16_bf16 v[64:79], v[144:147], v[244:247], v[64:79]
  v_add_f32 v25, v25, v224
  v_add_f32 v26, v26, v225
  v_add_f32 v25, v25, v226
  v_add_f32 v26, v26, v227
  s_waitcnt lgkmcnt(4)
  v_mfma_f32_32x32x16_bf16 v[80:95], v[148:151], v[244:247], v[80:95]
  v_add_f32 v25, v25, v228
  v_add_f32 v26, v26, v229
  v_add_f32 v25, v25, v230
  v_add_f32 v26, v26, v231
  s_waitcnt lgkmcnt(3)
  v_mfma_f32_32x32x16_bf16 v[96:111], v[152:155], v[244:247], v[96:111]
  v_add_f32 v25, v25, v26
  v_mov_b32 v26, v25
  s_nop 1
  v_permlane32_swap_b32 v26, v25
  s_waitcnt lgkmcnt(2)
  v_mfma_f32_32x32x16_bf16 v[112:127], v[156:159], v[244:247], v[112:127]
  s_nop 1
  v_add_f32 v25, v25, v26
  v_rcp_f32 v25, v25
  v_add_u32 v8, 0, v42
  v_add_u32 v9, 0, v43
  v_add_u32 v10, 65536, v42
  v_add_u32 v11, 65536, v43
  v_add_u32 v12, 131072, v42
  v_add_u32 v13, 131072, v43
  v_mov_b32 v24, v25
  v_mov_b32 v22, v44
  v_mov_b32 v23, 11
  v_pk_mul_f32 v[64:65], v[64:65], v[24:25]
  v_pk_mul_f32 v[66:67], v[66:67], v[24:25]
  v_pk_mul_f32 v[68:69], v[68:69], v[24:25]
  v_pk_mul_f32 v[70:71], v[70:71], v[24:25]
  v_cvt_pk_bf16_f32 v168, v64, v65
  v_cvt_pk_bf16_f32 v169, v66, v67
  v_cvt_pk_bf16_f32 v170, v68, v69
  v_cvt_pk_bf16_f32 v171, v70, v71
  buffer_store_dwordx4 v[168:171], v3, s[32:35], s48 offen offset:0 sc1
  v_pk_mul_f32 v[72:73], v[72:73], v[24:25]
  v_pk_mul_f32 v[74:75], v[74:75], v[24:25]
  v_pk_mul_f32 v[76:77], v[76:77], v[24:25]
  v_pk_mul_f32 v[78:79], v[78:79], v[24:25]
  v_cvt_pk_bf16_f32 v172, v72, v73
  v_cvt_pk_bf16_f32 v173, v74, v75
  v_cvt_pk_bf16_f32 v174, v76, v77
  v_cvt_pk_bf16_f32 v175, v78, v79
  buffer_store_dwordx4 v[172:175], v3, s[32:35], s48 offen offset:1024 sc1
  v_pk_mul_f32 v[80:81], v[80:81], v[24:25]
  v_pk_mul_f32 v[82:83], v[82:83], v[24:25]
  v_pk_mul_f32 v[84:85], v[84:85], v[24:25]
  v_pk_mul_f32 v[86:87], v[86:87], v[24:25]
  v_cvt_pk_bf16_f32 v176, v80, v81
  v_cvt_pk_bf16_f32 v177, v82, v83
  v_cvt_pk_bf16_f32 v178, v84, v85
  v_cvt_pk_bf16_f32 v179, v86, v87
  buffer_store_dwordx4 v[176:179], v3, s[32:35], s48 offen offset:2048 sc1
  v_pk_mul_f32 v[88:89], v[88:89], v[24:25]
  v_pk_mul_f32 v[90:91], v[90:91], v[24:25]
  v_pk_mul_f32 v[92:93], v[92:93], v[24:25]
  v_pk_mul_f32 v[94:95], v[94:95], v[24:25]
  v_cvt_pk_bf16_f32 v180, v88, v89
  v_cvt_pk_bf16_f32 v181, v90, v91
  v_cvt_pk_bf16_f32 v182, v92, v93
  v_cvt_pk_bf16_f32 v183, v94, v95
  buffer_store_dwordx4 v[180:183], v3, s[32:35], s48 offen offset:3072 sc1
  v_pk_mul_f32 v[96:97], v[96:97], v[24:25]
  v_pk_mul_f32 v[98:99], v[98:99], v[24:25]
  v_pk_mul_f32 v[100:101], v[100:101], v[24:25]
  v_pk_mul_f32 v[102:103], v[102:103], v[24:25]
  v_cvt_pk_bf16_f32 v184, v96, v97
  v_cvt_pk_bf16_f32 v185, v98, v99
  v_cvt_pk_bf16_f32 v186, v100, v101
  v_cvt_pk_bf16_f32 v187, v102, v103
  buffer_store_dwordx4 v[184:187], v4, s[32:35], s48 offen offset:0 sc1
  v_pk_mul_f32 v[104:105], v[104:105], v[24:25]
  v_pk_mul_f32 v[106:107], v[106:107], v[24:25]
  v_pk_mul_f32 v[108:109], v[108:109], v[24:25]
  v_pk_mul_f32 v[110:111], v[110:111], v[24:25]
  v_cvt_pk_bf16_f32 v188, v104, v105
  v_cvt_pk_bf16_f32 v189, v106, v107
  v_cvt_pk_bf16_f32 v190, v108, v109
  v_cvt_pk_bf16_f32 v191, v110, v111
  buffer_store_dwordx4 v[188:191], v4, s[32:35], s48 offen offset:1024 sc1
  v_pk_mul_f32 v[112:113], v[112:113], v[24:25]
  v_pk_mul_f32 v[114:115], v[114:115], v[24:25]
  v_pk_mul_f32 v[116:117], v[116:117], v[24:25]
  v_pk_mul_f32 v[118:119], v[118:119], v[24:25]
  v_cvt_pk_bf16_f32 v192, v112, v113
  v_cvt_pk_bf16_f32 v193, v114, v115
  v_cvt_pk_bf16_f32 v194, v116, v117
  v_cvt_pk_bf16_f32 v195, v118, v119
  buffer_store_dwordx4 v[192:195], v4, s[32:35], s48 offen offset:2048 sc1
  v_pk_mul_f32 v[120:121], v[120:121], v[24:25]
  v_pk_mul_f32 v[122:123], v[122:123], v[24:25]
  v_pk_mul_f32 v[124:125], v[124:125], v[24:25]
  v_pk_mul_f32 v[126:127], v[126:127], v[24:25]
  v_cvt_pk_bf16_f32 v196, v120, v121
  v_cvt_pk_bf16_f32 v197, v122, v123
  v_cvt_pk_bf16_f32 v198, v124, v125
  v_cvt_pk_bf16_f32 v199, v126, v127
  buffer_store_dwordx4 v[196:199], v4, s[32:35], s48 offen offset:3072 sc1
  s_waitcnt lgkmcnt(0)
L_NSPIN:
  v_readfirstlane_b32 s46, v16
  v_readfirstlane_b32 s47, v17
  s_cmp_lg_u32 s46, 0
  s_cbranch_scc1 L_NOK
  ds_read_b64 v[16:17], v31 offset:192
  s_waitcnt lgkmcnt(0)
  s_sub_u32 s14, s14, 1
  s_cbranch_scc1 L_ABORT
  s_branch L_NSPIN
L_NOK:
WW_17:
  ds_read_b32 v28, v31 offset:160
  s_waitcnt lgkmcnt(0)
  v_readfirstlane_b32 s12, v28
  s_cmp_lg_u32 s12, 0
  s_cbranch_scc1 WD_18
  s_sub_u32 s14, s14, 1
  s_cbranch_scc1 L_ABORT
  s_branch WW_17
WD_18:
  ds_read_b128 v[128:131], v12 offset:0
  ds_read_b128 v[132:135], v13 offset:1024
  ds_read_b128 v[136:139], v12 offset:2048
  ds_read_b128 v[140:143], v13 offset:3072
  ds_read_b128 v[144:147], v12 offset:4096
  ds_read_b128 v[148:151], v13 offset:5120
  s_waitcnt lgkmcnt(4)
  v_mfma_f32_32x32x16_bf16 v[32:47], v[128:131], v[168:171], 0
  ds_read_b128 v[152:155], v12 offset:6144
  ds_read_b128 v[156:159], v13 offset:7168
  v_mfma_f32_32x32x16_bf16 v[48:63], v[132:135], v[168:171], 0
  s_waitcnt lgkmcnt(4)
  v_mfma_f32_32x32x16_bf16 v[32:47], v[136:139], v[172:175], v[32:47]
  ds_read_b128 v[128:131], v12 offset:8192
  ds_read_b128 v[132:135], v13 offset:9216
  v_mfma_f32_32x32x16_bf16 v[48:63], v[140:143], v[172:175], v[48:63]
  s_waitcnt lgkmcnt(4)
  v_mfma_f32_32x32x16_bf16 v[32:47], v[144:147], v[176:179], v[32:47]
  ds_read_b128 v[136:139], v12 offset:10240
  ds_read_b128 v[140:143], v13 offset:11264
  v_mfma_f32_32x32x16_bf16 v[48:63], v[148:151], v[176:179], v[48:63]
  s_waitcnt lgkmcnt(4)
  v_mfma_f32_32x32x16_bf16 v[32:47], v[152:155], v[180:183], v[32:47]
  ds_read_b128 v[144:147], v12 offset:12288
  ds_read_b128 v[148:151], v13 offset:13312
  v_mfma_f32_32x32x16_bf16 v[48:63], v[156:159], v[180:183], v[48:63]
  s_waitcnt lgkmcnt(4)
  v_mfma_f32_32x32x16_bf16 v[32:47], v[128:131], v[184:187], v[32:47]
  ds_read_b128 v[152:155], v12 offset:14336
  ds_read_b128 v[156:159], v13 offset:15360
  v_mfma_f32_32x32x16_bf16 v[48:63], v[132:135], v[184:187], v[48:63]
  s_waitcnt lgkmcnt(4)
  v_mfma_f32_32x32x16_bf16 v[32:47], v[136:139], v[188:191], v[32:47]
  v_mfma_f32_32x32x16_bf16 v[48:63], v[140:143], v[188:191], v[48:63]
  s_waitcnt lgkmcnt(2)
  v_mfma_f32_32x32x16_bf16 v[32:47], v[144:147], v[192:195], v[32:47]
  v_mfma_f32_32x32x16_bf16 v[48:63], v[148:151], v[192:195], v[48:63]
  s_waitcnt lgkmcnt(0)
  v_mfma_f32_32x32x16_bf16 v[32:47], v[152:155], v[196:199], v[32:47]
  v_mfma_f32_32x32x16_bf16 v[48:63], v[156:159], v[196:199], v[48:63]
  s_waitcnt vmcnt(0)
  s_mov_b64 exec, 1
  buffer_store_dwordx2 v[16:17], v5, s[36:39], 0 offen
  s_mov_b64 exec, -1
  s_mov_b64 exec, 1
  ds_write_b32 v22, v23
  s_mov_b64 exec, -1
  s_mov_b32 s10, 12
  v_and_b32 v7, 0x7f, v6
L_PF:
  buffer_load_dwordx2 v[24:25], v7, s[36:39], 0 offen sc1
  s_waitcnt vmcnt(0)
  v_cmp_eq_u64 vcc, s[46:47], v[24:25]
  s_cmp_eq_u64 vcc, -1
  s_cbranch_scc1 L_PFOK
  s_sub_u32 s10, s10, 1
  s_cmp_lg_u32 s10, 0
  s_cbranch_scc1 L_PF
  s_mov_b64 exec, 1
  buffer_store_dwordx2 v[16:17], v5, s[36:39], 0 offen offset:128 sc1
  s_mov_b64 exec, -1
L_P1:
  buffer_load_dwordx2 v[24:25], v6, s[36:39], 0 offen sc1
  s_waitcnt vmcnt(0)
  v_cmp_eq_u64 vcc, s[46:47], v[24:25]
  s_lshr_b32 s9, vcc_lo, 8
  s_or_b32 s9, s9, vcc_lo
  s_and_b32 s9, s9, 0xff
  s_cmp_eq_u32 s9, 0xff
  s_mov_b32 s10, 0
  s_cbranch_scc1 L_P1D
  s_sub_u32 s14, s14, 1
  s_cbranch_scc1 L_ABORT
  s_branch L_P1
L_PFOK:
  s_mov_b32 s10, 1
L_P1D:
  s_mov_b32 s41, s10
  buffer_load_dwordx4 v[64:67], v3, s[32:35], s49 offen offset:0
  buffer_load_dwordx4 v[68:71], v3, s[32:35], s49 offen offset:1024
  buffer_load_dwordx4 v[72:75], v3, s[32:35], s49 offen offset:2048
  buffer_load_dwordx4 v[76:79], v3, s[32:35], s49 offen offset:3072
  buffer_load_dwordx4 v[80:83], v4, s[32:35], s49 offen offset:0
  buffer_load_dwordx4 v[84:87], v4, s[32:35], s49 offen offset:1024
  buffer_load_dwordx4 v[88:91], v4, s[32:35], s49 offen offset:2048
  buffer_load_dwordx4 v[92:95], v4, s[32:35], s49 offen offset:3072
  buffer_load_dwordx4 v[96:99], v3, s[32:35], s50 offen offset:0
  buffer_load_dwordx4 v[100:103], v3, s[32:35], s50 offen offset:1024
  buffer_load_dwordx4 v[104:107], v3, s[32:35], s50 offen offset:2048
  buffer_load_dwordx4 v[108:111], v3, s[32:35], s50 offen offset:3072
  v_mov_b32 v23, 12
  s_mov_b64 exec, 1
  ds_write_b32 v22, v23
  s_mov_b64 exec, -1
WO_19:
  ds_read_b64 v[24:25], v31 offset:160
  s_waitcnt lgkmcnt(0)
  v_min_u32 v24, v24, v25
  s_nop 0
  v_readfirstlane_b32 s12, v24
  s_cmp_lg_u32 s12, 0
  s_cbranch_scc1 WOD_20
  s_sub_u32 s14, s14, 1
  s_cbranch_scc1 L_ABORT
  s_branch WO_19
WOD_20:
  ds_read_b128 v[128:131], v10 offset:0
  ds_read_b128 v[132:135], v11 offset:1024
  ds_read_b128 v[136:139], v10 offset:2048
  ds_read_b128 v[140:143], v11 offset:3072
  ds_read_b128 v[144:147], v10 offset:4096
  ds_read_b128 v[148:151], v11 offset:5120
  s_waitcnt vmcnt(11) lgkmcnt(4)
  v_mfma_f32_32x32x16_bf16 v[32:47], v[128:131], v[64:67], v[32:47]
  ds_read_b128 v[152:155], v10 offset:6144
  ds_read_b128 v[156:159], v11 offset:7168
  v_mfma_f32_32x32x16_bf16 v[48:63], v[132:135], v[64:67], v[48:63]
  buffer_load_dwordx4 v[112:115], v4, s[32:35], s50 offen offset:0
  s_waitcnt vmcnt(11) lgkmcnt(4)
  v_mfma_f32_32x32x16_bf16 v[32:47], v[136:139], v[68:71], v[32:47]
  ds_read_b128 v[128:131], v10 offset:8192
  ds_read_b128 v[132:135], v11 offset:9216
  v_mfma_f32_32x32x16_bf16 v[48:63], v[140:143], v[68:71], v[48:63]
  buffer_load_dwordx4 v[116:119], v4, s[32:35], s50 offen offset:1024
  s_waitcnt vmcnt(11) lgkmcnt(4)
  v_mfma_f32_32x32x16_bf16 v[32:47], v[144:147], v[72:75], v[32:47]
  ds_read_b128 v[136:139], v10 offset:10240
  ds_read_b128 v[140:143], v11 offset:11264
  v_mfma_f32_32x32x16_bf16 v[48:63], v[148:151], v[72:75], v[48:63]
  buffer_load_dwordx4 v[120:123], v4, s[32:35], s50 offen offset:2048
  s_waitcnt vmcnt(11) lgkmcnt(4)
  v_mfma_f32_32x32x16_bf16 v[32:47], v[152:155], v[76:79], v[32:47]
  ds_read_b128 v[144:147], v10 offset:12288
  ds_read_b128 v[148:151], v11 offset:13312
  v_mfma_f32_32x32x16_bf16 v[48:63], v[156:159], v[76:79], v[48:63]
  buffer_load_dwordx4 v[124:127], v4, s[32:35], s50 offen offset:3072
  s_waitcnt vmcnt(11) lgkmcnt(4)
  v_mfma_f32_32x32x16_bf16 v[32:47], v[128:131], v[80:83], v[32:47]
  ds_read_b128 v[152:155], v10 offset:14336
  ds_read_b128 v[156:159], v11 offset:15360
  v_mfma_f32_32x32x16_bf16 v[48:63], v[132:135], v[80:83], v[48:63]
  buffer_load_dwordx4 v[200:203], v3, s[32:35], s51 offen offset:0
  s_waitcnt vmcnt(11) lgkmcnt(4)
  v_mfma_f32_32x32x16_bf16 v[32:47], v[136:139], v[84:87], v[32:47]
  v_mfma_f32_32x32x16_bf16 v[48:63], v[140:143], v[84:87], v[48:63]
WO_21:
  ds_read_b64 v[24:25], v31 offset:168
  s_waitcnt lgkmcnt(0)
  v_min_u32 v24, v24, v25
  s_nop 0
  v_readfirstlane_b32 s12, v24
  s_cmp_lg_u32 s12, 0
  s_cbranch_scc1 WOD_22
  s_sub_u32 s14, s14, 1
  s_cbranch_scc1 L_ABORT
  s_branch WO_21
WOD_22:
  ds_read_b128 v[128:131], v10 offset:16384
  ds_read_b128 v[132:135], v11 offset:17408
  buffer_load_dwordx4 v[204:207], v3, s[32:35], s51 offen offset:1024
  s_waitcnt vmcnt(11) lgkmcnt(4)
  v_mfma_f32_32x32x16_bf16 v[32:47], v[144:147], v[88:91], v[32:47]
  ds_read_b128 v[136:139], v10 offset:18432
  ds_read_b128 v[140:143], v11 offset:19456
  v_mfma_f32_32x32x16_bf16 v[48:63], v[148:151], v[88:91], v[48:63]
  buffer_load_dwordx4 v[208:211], v3, s[32:35], s51 offen offset:2048
  s_waitcnt vmcnt(11) lgkmcnt(4)
  v_mfma_f32_32x32x16_bf16 v[32:47], v[152:155], v[92:95], v[32:47]
  ds_read_b128 v[144:147], v10 offset:20480
  ds_read_b128 v[148:151], v11 offset:21504
  v_mfma_f32_32x32x16_bf16 v[48:63], v[156:159], v[92:95], v[48:63]
  buffer_load_dwordx4 v[212:215], v3, s[32:35], s51 offen offset:3072
  s_waitcnt vmcnt(11) lgkmcnt(4)
  v_mfma_f32_32x32x16_bf16 v[32:47], v[128:131], v[96:99], v[32:47]
  ds_read_b128 v[152:155], v10 offset:22528
  ds_read_b128 v[156:159], v11 offset:23552
  v_mfma_f32_32x32x16_bf16 v[48:63], v[132:135], v[96:99], v[48:63]
  buffer_load_dwordx4 v[216:219], v4, s[32:35], s51 offen offset:0
  s_waitcnt vmcnt(11) lgkmcnt(4)
  v_mfma_f32_32x32x16_bf16 v[32:47], v[136:139], v[100:103], v[32:47]
  ds_read_b128 v[128:131], v10 offset:24576
  ds_read_b128 v[132:135], v11 offset:25600
  v_mfma_f32_32x32x16_bf16 v[48:63], v[140:143], v[100:103], v[48:63]
  buffer_load_dwordx4 v[220:223], v4, s[32:35], s51 offen offset:1024
  s_waitcnt vmcnt(11) lgkmcnt(4)
  v_mfma_f32_32x32x16_bf16 v[32:47], v[144:147], v[104:107], v[32:47]
  ds_read_b128 v[136:139], v10 offset:26624
  ds_read_b128 v[140:143], v11 offset:27648
  v_mfma_f32_32x32x16_bf16 v[48:63], v[148:151], v[104:107], v[48:63]
  buffer_load_dwordx4 v[224:227], v4, s[32:35], s51 offen offset:2048
  s_waitcnt vmcnt(11) lgkmcnt(4)
  v_mfma_f32_32x32x16_bf16 v[32:47], v[152:155], v[108:111], v[32:47]
  ds_read_b128 v[144:147], v10 offset:28672
  ds_read_b128 v[148:151], v11 offset:29696
  v_mfma_f32_32x32x16_bf16 v[48:63], v[156:159], v[108:111], v[48:63]
  buffer_load_dwordx4 v[228:231], v4, s[32:35], s51 offen offset:3072
  s_waitcnt vmcnt(11) lgkmcnt(4)
  v_mfma_f32_32x32x16_bf16 v[32:47], v[128:131], v[112:115], v[32:47]
  ds_read_b128 v[152:155], v10 offset:30720
  ds_read_b128 v[156:159], v11 offset:31744
  v_mfma_f32_32x32x16_bf16 v[48:63], v[132:135], v[112:115], v[48:63]
  buffer_load_dwordx4 v[232:235], v3, s[32:35], s52 offen offset:0
  s_waitcnt vmcnt(11) lgkmcnt(4)
  v_mfma_f32_32x32x16_bf16 v[32:47], v[136:139], v[116:119], v[32:47]
  ds_read_b128 v[128:131], v10 offset:32768
  ds_read_b128 v[132:135], v11 offset:33792
  v_mfma_f32_32x32x16_bf16 v[48:63], v[140:143], v[116:119], v[48:63]
  buffer_load_dwordx4 v[236:239], v3, s[32:35], s52 offen offset:1024
  s_waitcnt vmcnt(11) lgkmcnt(4)
  v_mfma_f32_32x32x16_bf16 v[32:47], v[144:147], v[120:123], v[32:47]
  ds_read_b128 v[136:139], v10 offset:34816
  ds_read_b128 v[140:143], v11 offset:35840
  v_mfma_f32_32x32x16_bf16 v[48:63], v[148:151], v[120:123], v[48:63]
  buffer_load_dwordx4 v[240:243], v3, s[32:35], s52 offen offset:2048
  s_waitcnt vmcnt(11) lgkmcnt(4)
  v_mfma_f32_32x32x16_bf16 v[32:47], v[152:155], v[124:127], v[32:47]
  ds_read_b128 v[144:147], v10 offset:36864
  ds_read_b128 v[148:151], v11 offset:37888
  v_mfma_f32_32x32x16_bf16 v[48:63], v[156:159], v[124:127], v[48:63]
  buffer_load_dwordx4 v[244:247], v3, s[32:35], s52 offen offset:3072
  s_waitcnt vmcnt(11) lgkmcnt(4)
  v_mfma_f32_32x32x16_bf16 v[32:47], v[128:131], v[200:203], v[32:47]
  ds_read_b128 v[152:155], v10 offset:38912
  ds_read_b128 v[156:159], v11 offset:39936
  v_mfma_f32_32x32x16_bf16 v[48:63], v[132:135], v[200:203], v[48:63]
  buffer_load_dwordx4 v[64:67], v4, s[32:35], s52 offen offset:0
  s_waitcnt vmcnt(11) lgkmcnt(4)
  v_mfma_f32_32x32x16_bf16 v[32:47], v[136:139], v[204:207], v[32:47]
  ds_read_b128 v[128:131], v10 offset:40960
  ds_read_b128 v[132:135], v11 offset:41984
  v_mfma_f32_32x32x16_bf16 v[48:63], v[140:143], v[204:207], v[48:63]
  buffer_load_dwordx4 v[68:71], v4, s[32:35], s52 offen offset:1024
  s_waitcnt vmcnt(11) lgkmcnt(4)
  v_mfma_f32_32x32x16_bf16 v[32:47], v[144:147], v[208:211], v[32:47]
  ds_read_b128 v[136:139], v10 offset:43008
  ds_read_b128 v[140:143], v11 offset:44032
  v_mfma_f32_32x32x16_bf16 v[48:63], v[148:151], v[208:211], v[48:63]
  buffer_load_dwordx4 v[72:75], v4, s[32:35], s52 offen offset:2048
  s_waitcnt vmcnt(11) lgkmcnt(4)
  v_mfma_f32_32x32x16_bf16 v[32:47], v[152:155], v[212:215], v[32:47]
  ds_read_b128 v[144:147], v10 offset:45056
  ds_read_b128 v[148:151], v11 offset:46080
  v_mfma_f32_32x32x16_bf16 v[48:63], v[156:159], v[212:215], v[48:63]
  buffer_load_dwordx4 v[76:79], v4, s[32:35], s52 offen offset:3072
  s_waitcnt vmcnt(11) lgkmcnt(4)
  v_mfma_f32_32x32x16_bf16 v[32:47], v[128:131], v[216:219], v[32:47]
  ds_read_b128 v[152:155], v10 offset:47104
  ds_read_b128 v[156:159], v11 offset:48128
  v_mfma_f32_32x32x16_bf16 v[48:63], v[132:135], v[216:219], v[48:63]
  buffer_load_dwordx4 v[80:83], v3, s[32:35], s53 offen offset:0
  s_waitcnt vmcnt(11) lgkmcnt(4)
  v_mfma_f32_32x32x16_bf16 v[32:47], v[136:139], v[220:223], v[32:47]
  v_mfma_f32_32x32x16_bf16 v[48:63], v[140:143], v[220:223], v[48:63]
WO_23:
  ds_read_b64 v[24:25], v31 offset:176
  s_waitcnt lgkmcnt(0)
  v_min_u32 v24, v24, v25
  s_nop 0
  v_readfirstlane_b32 s12, v24
  s_cmp_lg_u32 s12, 0
  s_cbranch_scc1 WOD_24
  s_sub_u32 s14, s14, 1
  s_cbranch_scc1 L_ABORT
  s_branch WO_23
WOD_24:
  ds_read_b128 v[128:131], v10 offset:49152
  ds_read_b128 v[132:135], v11 offset:50176
  buffer_load_dwordx4 v[84:87], v3, s[32:35], s53 offen offset:1024
  s_waitcnt vmcnt(11) lgkmcnt(4)
  v_mfma_f32_32x32x16_bf16 v[32:47], v[144:147], v[224:227], v[32:47]
  ds_read_b128 v[136:139], v10 offset:51200
  ds_read_b128 v[140:143], v11 offset:52224
  v_mfma_f32_32x32x16_bf16 v[48:63], v[148:151], v[224:227], v[48:63]
  buffer_load_dwordx4 v[88:91], v3, s[32:35], s53 offen offset:2048
  s_waitcnt vmcnt(11) lgkmcnt(4)
  v_mfma_f32_32x32x16_bf16 v[32:47], v[152:155], v[228:231], v[32:47]
  ds_read_b128 v[144:147], v10 offset:53248
  ds_read_b128 v[148:151], v11 offset:54272
  v_mfma_f32_32x32x16_bf16 v[48:63], v[156:159], v[228:231], v[48:63]
  buffer_load_dwordx4 v[92:95], v3, s[32:35], s53 offen offset:3072
  s_waitcnt vmcnt(11) lgkmcnt(4)
  v_mfma_f32_32x32x16_bf16 v[32:47], v[128:131], v[232:235], v[32:47]
  ds_read_b128 v[152:155], v10 offset:55296
  ds_read_b128 v[156:159], v11 offset:56320
  v_mfma_f32_32x32x16_bf16 v[48:63], v[132:135], v[232:235], v[48:63]
  buffer_load_dwordx4 v[96:99], v4, s[32:35], s53 offen offset:0
  s_waitcnt vmcnt(11) lgkmcnt(4)
  v_mfma_f32_32x32x16_bf16 v[32:47], v[136:139], v[236:239], v[32:47]
  ds_read_b128 v[128:131], v10 offset:57344
  ds_read_b128 v[132:135], v11 offset:58368
  v_mfma_f32_32x32x16_bf16 v[48:63], v[140:143], v[236:239], v[48:63]
  buffer_load_dwordx4 v[100:103], v4, s[32:35], s53 offen offset:1024
  s_waitcnt vmcnt(11) lgkmcnt(4)
  v_mfma_f32_32x32x16_bf16 v[32:47], v[144:147], v[240:243], v[32:47]
  ds_read_b128 v[136:139], v10 offset:59392
  ds_read_b128 v[140:143], v11 offset:60416
  v_mfma_f32_32x32x16_bf16 v[48:63], v[148:151], v[240:243], v[48:63]
  buffer_load_dwordx4 v[104:107], v4, s[32:35], s53 offen offset:2048
  s_waitcnt vmcnt(11) lgkmcnt(4)
  v_mfma_f32_32x32x16_bf16 v[32:47], v[152:155], v[244:247], v[32:47]
  ds_read_b128 v[144:147], v10 offset:61440
  ds_read_b128 v[148:151], v11 offset:62464
  v_mfma_f32_32x32x16_bf16 v[48:63], v[156:159], v[244:247], v[48:63]
  buffer_load_dwordx4 v[108:111], v4, s[32:35], s53 offen offset:3072
  s_waitcnt vmcnt(11) lgkmcnt(4)
  v_mfma_f32_32x32x16_bf16 v[32:47], v[128:131], v[64:67], v[32:47]
  ds_read_b128 v[152:155], v10 offset:63488
  ds_read_b128 v[156:159], v11 offset:64512
  v_mfma_f32_32x32x16_bf16 v[48:63], v[132:135], v[64:67], v[48:63]
  buffer_load_dwordx4 v[112:115], v3, s[32:35], s54 offen offset:0
  s_waitcnt vmcnt(11) lgkmcnt(4)
  v_mfma_f32_32x32x16_bf16 v[32:47], v[136:139], v[68:71], v[32:47]
  ds_read_b128 v[128:131], v8 offset:0
  ds_read_b128 v[132:135], v9 offset:1024
  v_mfma_f32_32x32x16_bf16 v[48:63], v[140:143], v[68:71], v[48:63]
  buffer_load_dwordx4 v[116:119], v3, s[32:35], s54 offen offset:1024
  s_waitcnt vmcnt(11) lgkmcnt(4)
  v_mfma_f32_32x32x16_bf16 v[32:47], v[144:147], v[72:75], v[32:47]
  ds_read_b128 v[136:139], v8 offset:2048
  ds_read_b128 v[140:143], v9 offset:3072
  v_mfma_f32_32x32x16_bf16 v[48:63], v[148:151], v[72:75], v[48:63]
  buffer_load_dwordx4 v[120:123], v3, s[32:35], s54 offen offset:2048
  s_waitcnt vmcnt(11) lgkmcnt(4)
  v_mfma_f32_32x32x16_bf16 v[32:47], v[152:155], v[76:79], v[32:47]
  ds_read_b128 v[144:147], v8 offset:4096
  ds_read_b128 v[148:151], v9 offset:5120
  v_mfma_f32_32x32x16_bf16 v[48:63], v[156:159], v[76:79], v[48:63]
  buffer_load_dwordx4 v[124:127], v3, s[32:35], s54 offen offset:3072
  s_waitcnt vmcnt(11) lgkmcnt(4)
  v_mfma_f32_32x32x16_bf16 v[32:47], v[128:131], v[80:83], v[32:47]
  ds_read_b128 v[152:155], v8 offset:6144
  ds_read_b128 v[156:159], v9 offset:7168
  v_mfma_f32_32x32x16_bf16 v[48:63], v[132:135], v[80:83], v[48:63]
  buffer_load_dwordx4 v[200:203], v4, s[32:35], s54 offen offset:0
  s_waitcnt vmcnt(11) lgkmcnt(4)
  v_mfma_f32_32x32x16_bf16 v[32:47], v[136:139], v[84:87], v[32:47]
  ds_read_b128 v[128:131], v8 offset:8192
  ds_read_b128 v[132:135], v9 offset:9216
  v_mfma_f32_32x32x16_bf16 v[48:63], v[140:143], v[84:87], v[48:63]
  buffer_load_dwordx4 v[204:207], v4, s[32:35], s54 offen offset:1024
  s_waitcnt vmcnt(11) lgkmcnt(4)
  v_mfma_f32_32x32x16_bf16 v[32:47], v[144:147], v[88:91], v[32:47]
  ds_read_b128 v[136:139], v8 offset:10240
  ds_read_b128 v[140:143], v9 offset:11264
  v_mfma_f32_32x32x16_bf16 v[48:63], v[148:151], v[88:91], v[48:63]
  buffer_load_dwordx4 v[208:211], v4, s[32:35], s54 offen offset:2048
  s_waitcnt vmcnt(11) lgkmcnt(4)
  v_mfma_f32_32x32x16_bf16 v[32:47], v[152:155], v[92:95], v[32:47]
  ds_read_b128 v[144:147], v8 offset:12288
  ds_read_b128 v[148:151], v9 offset:13312
  v_mfma_f32_32x32x16_bf16 v[48:63], v[156:159], v[92:95], v[48:63]
  buffer_load_dwordx4 v[212:215], v4, s[32:35], s54 offen offset:3072
  s_waitcnt vmcnt(11) lgkmcnt(4)
  v_mfma_f32_32x32x16_bf16 v[32:47], v[128:131], v[96:99], v[32:47]
  ds_read_b128 v[152:155], v8 offset:14336
  ds_read_b128 v[156:159], v9 offset:15360
  v_mfma_f32_32x32x16_bf16 v[48:63], v[132:135], v[96:99], v[48:63]
  buffer_load_dwordx4 v[216:219], v3, s[32:35], s55 offen offset:0
  s_waitcnt vmcnt(11) lgkmcnt(4)
  v_mfma_f32_32x32x16_bf16 v[32:47], v[136:139], v[100:103], v[32:47]
  v_mfma_f32_32x32x16_bf16 v[48:63], v[140:143], v[100:103], v[48:63]
WO_25:
  ds_read_b64 v[24:25], v31 offset:184
  s_waitcnt lgkmcnt(0)
  v_min_u32 v24, v24, v25
  s_nop 0
  v_readfirstlane_b32 s12, v24
  s_cmp_lg_u32 s12, 0
  s_cbranch_scc1 WOD_26
  s_sub_u32 s14, s14, 1
  s_cbranch_scc1 L_ABORT
  s_branch WO_25
WOD_26:
  ds_read_b128 v[128:131], v8 offset:16384
  ds_read_b128 v[132:135], v9 offset:17408
  buffer_load_dwordx4 v[220:223], v3, s[32:35], s55 offen offset:1024
  s_waitcnt vmcnt(11) lgkmcnt(4)
  v_mfma_f32_32x32x16_bf16 v[32:47], v[144:147], v[104:107], v[32:47]
  ds_read_b128 v[136:139], v8 offset:18432
  ds_read_b128 v[140:143], v9 offset:19456
  v_mfma_f32_32x32x16_bf16 v[48:63], v[148:151], v[104:107], v[48:63]
  buffer_load_dwordx4 v[224:227], v3, s[32:35], s55 offen offset:2048
  s_waitcnt vmcnt(11) lgkmcnt(4)
  v_mfma_f32_32x32x16_bf16 v[32:47], v[152:155], v[108:111], v[32:47]
  ds_read_b128 v[144:147], v8 offset:20480
  ds_read_b128 v[148:151], v9 offset:21504
  v_mfma_f32_32x32x16_bf16 v[48:63], v[156:159], v[108:111], v[48:63]
  buffer_load_dwordx4 v[228:231], v3, s[32:35], s55 offen offset:3072
  s_waitcnt vmcnt(11) lgkmcnt(4)
  v_mfma_f32_32x32x16_bf16 v[32:47], v[128:131], v[112:115], v[32:47]
  ds_read_b128 v[152:155], v8 offset:22528
  ds_read_b128 v[156:159], v9 offset:23552
  v_mfma_f32_32x32x16_bf16 v[48:63], v[132:135], v[112:115], v[48:63]
  buffer_load_dwordx4 v[232:235], v4, s[32:35], s55 offen offset:0
  s_waitcnt vmcnt(11) lgkmcnt(4)
  v_mfma_f32_32x32x16_bf16 v[32:47], v[136:139], v[116:119], v[32:47]
  ds_read_b128 v[128:131], v8 offset:24576
  ds_read_b128 v[132:135], v9 offset:25600
  v_mfma_f32_32x32x16_bf16 v[48:63], v[140:143], v[116:119], v[48:63]
  buffer_load_dwordx4 v[236:239], v4, s[32:35], s55 offen offset:1024
  s_waitcnt vmcnt(11) lgkmcnt(4)
  v_mfma_f32_32x32x16_bf16 v[32:47], v[144:147], v[120:123], v[32:47]
  ds_read_b128 v[136:139], v8 offset:26624
  ds_read_b128 v[140:143], v9 offset:27648
  v_mfma_f32_32x32x16_bf16 v[48:63], v[148:151], v[120:123], v[48:63]
  buffer_load_dwordx4 v[240:243], v4, s[32:35], s55 offen offset:2048
  s_waitcnt vmcnt(11) lgkmcnt(4)
  v_mfma_f32_32x32x16_bf16 v[32:47], v[152:155], v[124:127], v[32:47]
  ds_read_b128 v[144:147], v8 offset:28672
  ds_read_b128 v[148:151], v9 offset:29696
  v_mfma_f32_32x32x16_bf16 v[48:63], v[156:159], v[124:127], v[48:63]
  buffer_load_dwordx4 v[244:247], v4, s[32:35], s55 offen offset:3072
  s_waitcnt vmcnt(11) lgkmcnt(4)
  v_mfma_f32_32x32x16_bf16 v[32:47], v[128:131], v[200:203], v[32:47]
  ds_read_b128 v[152:155], v8 offset:30720
  ds_read_b128 v[156:159], v9 offset:31744
  v_mfma_f32_32x32x16_bf16 v[48:63], v[132:135], v[200:203], v[48:63]
  s_waitcnt vmcnt(10) lgkmcnt(4)
  v_mfma_f32_32x32x16_bf16 v[32:47], v[136:139], v[204:207], v[32:47]
  ds_read_b128 v[128:131], v8 offset:32768
  ds_read_b128 v[132:135], v9 offset:33792
  v_mfma_f32_32x32x16_bf16 v[48:63], v[140:143], v[204:207], v[48:63]
  s_waitcnt vmcnt(9) lgkmcnt(4)
  v_mfma_f32_32x32x16_bf16 v[32:47], v[144:147], v[208:211], v[32:47]
  ds_read_b128 v[136:139], v8 offset:34816
  ds_read_b128 v[140:143], v9 offset:35840
  v_mfma_f32_32x32x16_bf16 v[48:63], v[148:151], v[208:211], v[48:63]
  s_waitcnt vmcnt(8) lgkmcnt(4)
  v_mfma_f32_32x32x16_bf16 v[32:47], v[152:155], v[212:215], v[32:47]
  ds_read_b128 v[144:147], v8 offset:36864
  ds_read_b128 v[148:151], v9 offset:37888
  v_mfma_f32_32x32x16_bf16 v[48:63], v[156:159], v[212:215], v[48:63]
  s_waitcnt vmcnt(7) lgkmcnt(4)
  v_mfma_f32_32x32x16_bf16 v[32:47], v[128:131], v[216:219], v[32:47]
  ds_read_b128 v[152:155], v8 offset:38912
  ds_read_b128 v[156:159], v9 offset:39936
  v_mfma_f32_32x32x16_bf16 v[48:63], v[132:135], v[216:219], v[48:63]
  s_waitcnt vmcnt(6) lgkmcnt(4)
  v_mfma_f32_32x32x16_bf16 v[32:47], v[136:139], v[220:223], v[32:47]
  ds_read_b128 v[128:131], v8 offset:40960
  ds_read_b128 v[132:135], v9 offset:41984
  v_mfma_f32_32x32x16_bf16 v[48:63], v[140:143], v[220:223], v[48:63]
  s_waitcnt vmcnt(5) lgkmcnt(4)
  v_mfma_f32_32x32x16_bf16 v[32:47], v[144:147], v[224:227], v[32:47]
  ds_read_b128 v[136:139], v8 offset:43008
  ds_read_b128 v[140:143], v9 offset:44032
  v_mfma_f32_32x32x16_bf16 v[48:63], v[148:151], v[224:227], v[48:63]
  s_waitcnt vmcnt(4) lgkmcnt(4)
  v_mfma_f32_32x32x16_bf16 v[32:47], v[152:155], v[228:231], v[32:47]
  ds_read_b128 v[144:147], v8 offset:45056
  ds_read_b128 v[148:151], v9 offset:46080
  v_mfma_f32_32x32x16_bf16 v[48:63], v[156:159], v[228:231], v[48:63]
  s_waitcnt vmcnt(3) lgkmcnt(4)
  v_mfma_f32_32x32x16_bf16 v[32:47], v[128:131], v[232:235], v[32:47]
  ds_read_b128 v[152:155], v8 offset:47104
  ds_read_b128 v[156:159], v9 offset:48128
  v_mfma_f32_32x32x16_bf16 v[48:63], v[132:135], v[232:235], v[48:63]
  s_waitcnt vmcnt(2) lgkmcnt(4)
  v_mfma_f32_32x32x16_bf16 v[32:47], v[136:139], v[236:239], v[32:47]
  v_mfma_f32_32x32x16_bf16 v[48:63], v[140:143], v[236:239], v[48:63]
  s_waitcnt vmcnt(1) lgkmcnt(2)
  v_mfma_f32_32x32x16_bf16 v[32:47], v[144:147], v[240:243], v[32:47]
  v_mfma_f32_32x32x16_bf16 v[48:63], v[148:151], v[240:243], v[48:63]
  s_waitcnt vmcnt(0) lgkmcnt(0)
  v_mfma_f32_32x32x16_bf16 v[32:47], v[152:155], v[244:247], v[32:47]
  v_mfma_f32_32x32x16_bf16 v[48:63], v[156:159], v[244:247], v[48:63]
  s_cmp_eq_u32 s41, 0
  s_cbranch_scc1 L_NOOWE
  s_mov_b64 exec, 1
  buffer_store_dwordx2 v[16:17], v5, s[36:39], 0 offen offset:128 sc1
  s_mov_b64 exec, -1
L_NOOWE:
  s_lshl_b32 s9, s5, 3
  s_add_u32 s9, s9, s6
  s_lshl_b32 s9, s9, 2
  s_add_u32 s9, s9, s3
  s_lshl_b32 s10, s9, 7
  s_add_u32 s10, s10, 16908288
  s_add_u32 s36, s30, s10
  s_addc_u32 s37, s31, 0
  s_and_b32 s37, s37, 0xffff
  s_sub_u32 s38, 268435456, s10
  s_mov_b32 s39, 0x20000
  s_lshl_b32 s9, s9, 15
  s_add_u32 s9, s9, 8388608
  s_add_u32 s32, s30, s9
  s_addc_u32 s33, s31, 0
  s_and_b32 s33, s33, 0xffff
  s_sub_u32 s34, 16777216, s9
  s_mov_b32 s35, 0x20000
  s_cmp_eq_u32 s3, s4
  s_cbranch_scc1 L_RED
  s_lshl_b32 s11, s4, 13
  s_lshl_b32 s10, s4, 3
  v_mov_b32 v5, s10
  buffer_store_dwordx4 v[32:35], v3, s[32:35], s11 offen offset:0 sc1
  buffer_store_dwordx4 v[36:39], v3, s[32:35], s11 offen offset:1024 sc1
  buffer_store_dwordx4 v[40:43], v3, s[32:35], s11 offen offset:2048 sc1
  buffer_store_dwordx4 v[44:47], v3, s[32:35], s11 offen offset:3072 sc1
  buffer_store_dwordx4 v[48:51], v4, s[32:35], s11 offen offset:0 sc1
  buffer_store_dwordx4 v[52:55], v4, s[32:35], s11 offen offset:1024 sc1
  buffer_store_dwordx4 v[56:59], v4, s[32:35], s11 offen offset:2048 sc1
  buffer_store_dwordx4 v[60:63], v4, s[32:35], s11 offen offset:3072 sc1
  s_waitcnt vmcnt(0)
  s_mov_b64 exec, 1
  buffer_store_dwordx2 v[16:17], v5, s[36:39], 0 offen sc1
  s_mov_b64 exec, -1
  s_endpgm
L_RED:
  v_and_b32 v6, 3, v0
  s_xor_b32 s10, s4, 1
  v_mov_b32 v15, s10
  v_cmp_eq_u32 vcc, s4, v6
  s_nop 1
  v_cndmask_b32 v6, v6, v15, vcc
  v_lshlrev_b32 v6, 3, v6
  s_lshl_b32 s9, s5, 2
  s_add_u32 s9, s9, s3
  s_lshl_b32 s9, s9, 15
  s_lshl_b32 s10, s6, 7
  s_add_u32 s9, s9, s10
  s_add_u32 s88, s26, s9
  s_addc_u32 s89, s27, 0
  s_and_b32 s89, s89, 0xffff
  s_sub_u32 s90, 1048576, s9
  s_mov_b32 s91, 0x20000
  v_lshlrev_b32 v15, 10, v1
  v_lshl_add_u32 v15, v2, 4, v15
  s_add_u32 s49, s4, 1
  s_and_b32 s49, s49, 3
  s_lshl_b32 s49, s49, 13
  s_add_u32 s50, s4, 2
  s_and_b32 s50, s50, 3
  s_lshl_b32 s50, s50, 13
  s_add_u32 s51, s4, 3
  s_and_b32 s51, s51, 3
  s_lshl_b32 s51, s51, 13
L_P2:
  buffer_load_dwordx2 v[24:25], v6, s[36:39], 0 offen sc1
  s_waitcnt vmcnt(0)
  v_cmp_eq_u64 vcc, s[46:47], v[24:25]
  s_cmp_eq_u64 vcc, -1
  s_cbranch_scc1 L_P2D
  s_sub_u32 s14, s14, 1
  s_cbranch_scc1 L_ABORT
  s_branch L_P2
L_P2D:
  buffer_load_dwordx4 v[64:67], v3, s[32:35], s49 offen offset:0 sc1
  buffer_load_dwordx4 v[68:71], v3, s[32:35], s49 offen offset:1024 sc1
  buffer_load_dwordx4 v[72:75], v3, s[32:35], s49 offen offset:2048 sc1
  buffer_load_dwordx4 v[76:79], v3, s[32:35], s49 offen offset:3072 sc1
  buffer_load_dwordx4 v[80:83], v4, s[32:35], s49 offen offset:0 sc1
  buffer_load_dwordx4 v[84:87], v4, s[32:35], s49 offen offset:1024 sc1
  buffer_load_dwordx4 v[88:91], v4, s[32:35], s49 offen offset:2048 sc1
  buffer_load_dwordx4 v[92:95], v4, s[32:35], s49 offen offset:3072 sc1
  buffer_load_dwordx4 v[96:99], v3, s[32:35], s50 offen offset:0 sc1
  buffer_load_dwordx4 v[100:103], v3, s[32:35], s50 offen offset:1024 sc1
  buffer_load_dwordx4 v[104:107], v3, s[32:35], s50 offen offset:2048 sc1
  buffer_load_dwordx4 v[108:111], v3, s[32:35], s50 offen offset:3072 sc1
  buffer_load_dwordx4 v[112:115], v4, s[32:35], s50 offen offset:0 sc1
  buffer_load_dwordx4 v[116:119], v4, s[32:35], s50 offen offset:1024 sc1
  buffer_load_dwordx4 v[120:123], v4, s[32:35], s50 offen offset:2048 sc1
  buffer_load_dwordx4 v[124:127], v4, s[32:35], s50 offen offset:3072 sc1
  buffer_load_dwordx4 v[128:131], v3, s[32:35], s51 offen offset:0 sc1
  buffer_load_dwordx4 v[132:135], v3, s[32:35], s51 offen offset:1024 sc1
  buffer_load_dwordx4 v[136:139], v3, s[32:35], s51 offen offset:2048 sc1
  buffer_load_dwordx4 v[140:143], v3, s[32:35], s51 offen offset:3072 sc1
  buffer_load_dwordx4 v[144:147], v4, s[32:35], s51 offen offset:0 sc1
  buffer_load_dwordx4 v[148:151], v4, s[32:35], s51 offen offset:1024 sc1
  buffer_load_dwordx4 v[152:155], v4, s[32:35], s51 offen offset:2048 sc1
  buffer_load_dwordx4 v[156:159], v4, s[32:35], s51 offen offset:3072 sc1
  s_waitcnt vmcnt(23)
  v_add_f32 v32, v32, v64
  v_add_f32 v33, v33, v65
  v_add_f32 v34, v34, v66
  v_add_f32 v35, v35, v67
  s_waitcnt vmcnt(22)
  v_add_f32 v36, v36, v68
  v_add_f32 v37, v37, v69
  v_add_f32 v38, v38, v70
  v_add_f32 v39, v39, v71
  s_waitcnt vmcnt(21)
  v_add_f32 v40, v40, v72
  v_add_f32 v41, v41, v73
  v_add_f32 v42, v42, v74
  v_add_f32 v43, v43, v75
  s_waitcnt vmcnt(20)
  v_add_f32 v44, v44, v76
  v_add_f32 v45, v45, v77
  v_add_f32 v46, v46, v78
  v_add_f32 v47, v47, v79
  s_waitcnt vmcnt(19)
  v_add_f32 v48, v48, v80
  v_add_f32 v49, v49, v81
  v_add_f32 v50, v50, v82
  v_add_f32 v51, v51, v83
  s_waitcnt vmcnt(18)
  v_add_f32 v52, v52, v84
  v_add_f32 v53, v53, v85
  v_add_f32 v54, v54, v86
  v_add_f32 v55, v55, v87
  s_waitcnt vmcnt(17)
  v_add_f32 v56, v56, v88
  v_add_f32 v57, v57, v89
  v_add_f32 v58, v58, v90
  v_add_f32 v59, v59, v91
  s_waitcnt vmcnt(16)
  v_add_f32 v60, v60, v92
  v_add_f32 v61, v61, v93
  v_add_f32 v62, v62, v94
  v_add_f32 v63, v63, v95
  s_waitcnt vmcnt(15)
  v_add_f32 v32, v32, v96
  v_add_f32 v33, v33, v97
  v_add_f32 v34, v34, v98
  v_add_f32 v35, v35, v99
  s_waitcnt vmcnt(14)
  v_add_f32 v36, v36, v100
  v_add_f32 v37, v37, v101
  v_add_f32 v38, v38, v102
  v_add_f32 v39, v39, v103
  s_waitcnt vmcnt(13)
  v_add_f32 v40, v40, v104
  v_add_f32 v41, v41, v105
  v_add_f32 v42, v42, v106
  v_add_f32 v43, v43, v107
  s_waitcnt vmcnt(12)
  v_add_f32 v44, v44, v108
  v_add_f32 v45, v45, v109
  v_add_f32 v46, v46, v110
  v_add_f32 v47, v47, v111
  s_waitcnt vmcnt(11)
  v_add_f32 v48, v48, v112
  v_add_f32 v49, v49, v113
  v_add_f32 v50, v50, v114
  v_add_f32 v51, v51, v115
  s_waitcnt vmcnt(10)
  v_add_f32 v52, v52, v116
  v_add_f32 v53, v53, v117
  v_add_f32 v54, v54, v118
  v_add_f32 v55, v55, v119
  s_waitcnt vmcnt(9)
  v_add_f32 v56, v56, v120
  v_add_f32 v57, v57, v121
  v_add_f32 v58, v58, v122
  v_add_f32 v59, v59, v123
  s_waitcnt vmcnt(8)
  v_add_f32 v60, v60, v124
  v_add_f32 v61, v61, v125
  v_add_f32 v62, v62, v126
  v_add_f32 v63, v63, v127
  s_waitcnt vmcnt(7)
  v_add_f32 v32, v32, v128
  v_add_f32 v33, v33, v129
  v_add_f32 v34, v34, v130
  v_add_f32 v35, v35, v131
  s_waitcnt vmcnt(6)
  v_add_f32 v36, v36, v132
  v_add_f32 v37, v37, v133
  v_add_f32 v38, v38, v134
  v_add_f32 v39, v39, v135
  s_waitcnt vmcnt(5)
  v_add_f32 v40, v40, v136
  v_add_f32 v41, v41, v137
  v_add_f32 v42, v42, v138
  v_add_f32 v43, v43, v139
  s_waitcnt vmcnt(4)
  v_add_f32 v44, v44, v140
  v_add_f32 v45, v45, v141
  v_add_f32 v46, v46, v142
  v_add_f32 v47, v47, v143
  s_waitcnt vmcnt(3)
  v_add_f32 v48, v48, v144
  v_add_f32 v49, v49, v145
  v_add_f32 v50, v50, v146
  v_add_f32 v51, v51, v147
  s_waitcnt vmcnt(2)
  v_add_f32 v52, v52, v148
  v_add_f32 v53, v53, v149
  v_add_f32 v54, v54, v150
  v_add_f32 v55, v55, v151
  s_waitcnt vmcnt(1)
  v_add_f32 v56, v56, v152
  v_add_f32 v57, v57, v153
  v_add_f32 v58, v58, v154
  v_add_f32 v59, v59, v155
  s_waitcnt vmcnt(0)
  v_add_f32 v60, v60, v156
  v_add_f32 v61, v61, v157
  v_add_f32 v62, v62, v158
  v_add_f32 v63, v63, v159
  v_cvt_pk_bf16_f32 v64, v32, v33
  v_cvt_pk_bf16_f32 v65, v34, v35
  v_cvt_pk_bf16_f32 v66, v36, v37
  v_cvt_pk_bf16_f32 v67, v38, v39
  v_cvt_pk_bf16_f32 v68, v40, v41
  v_cvt_pk_bf16_f32 v69, v42, v43
  v_cvt_pk_bf16_f32 v70, v44, v45
  v_cvt_pk_bf16_f32 v71, v46, v47
  v_cvt_pk_bf16_f32 v72, v48, v49
  v_cvt_pk_bf16_f32 v73, v50, v51
  v_cvt_pk_bf16_f32 v74, v52, v53
  v_cvt_pk_bf16_f32 v75, v54, v55
  v_cvt_pk_bf16_f32 v76, v56, v57
  v_cvt_pk_bf16_f32 v77, v58, v59
  v_cvt_pk_bf16_f32 v78, v60, v61
  v_cvt_pk_bf16_f32 v79, v62, v63
  buffer_store_dwordx4 v[64:67], v15, s[88:91], 0 offen offset:0
  buffer_store_dwordx4 v[68:71], v15, s[88:91], 0 offen offset:32
  buffer_store_dwordx4 v[72:75], v15, s[88:91], 0 offen offset:64
  buffer_store_dwordx4 v[76:79], v15, s[88:91], 0 offen offset:96
  s_endpgm
L_KV:
  s_and_b32 s45, s3, 1
  s_lshl_b32 s9, s5, 1
  s_add_u32 s9, s9, s45
  s_lshl_b32 s9, s9, 5
  s_add_u32 s9, s9, s7
  s_lshl_b32 s9, s9, 14
  s_add_u32 s32, s18, s9
  s_addc_u32 s33, s19, 0
  s_and_b32 s33, s33, 0xffff
  s_sub_u32 s34, 8388608, s9
  s_mov_b32 s35, 0x20000
  s_add_u32 s88, s20, s9
  s_addc_u32 s89, s21, 0
  s_and_b32 s89, s89, 0xffff
  s_sub_u32 s90, 8388608, s9
  s_mov_b32 s91, 0x20000
  s_mov_b32 s36, s28
  s_and_b32 s37, s29, 0xffff
  s_mov_b32 s38, 256
  s_mov_b32 s39, 0x20000
  v_mov_b32 v15, 0
  s_lshl_b32 s10, s2, 1
  s_add_u32 s10, s10, s45
  s_cmp_lg_u32 s10, 1
  s_cbranch_scc1 L_LV1
  s_memrealtime s[46:47]
  s_waitcnt lgkmcnt(0)
  s_or_b32 s46, s46, 1
  v_mov_b32 v6, s46
  v_mov_b32 v7, s47
  s_mov_b64 exec, 1
  buffer_store_dwordx2 v[6:7], v15, s[36:39], 0 offen sc1
  s_mov_b64 exec, -1
L_LV1:
  s_lshl_b32 s10, s45, 14
  v_lshrrev_b32 v1, 4, v0
  v_add_u32 v2, 0, v1
  v_and_b32 v3, 15, v0
  v_xor_b32 v2, v2, v3
  v_lshlrev_b32 v2, 4, v2
  v_lshl_add_u32 v8, v1, 8, v2
  v_add_u32 v8, s10, v8
  v_lshrrev_b32 v1, 4, v0
  v_add_u32 v2, 4, v1
  v_and_b32 v3, 15, v0
  v_xor_b32 v2, v2, v3
  v_lshlrev_b32 v2, 4, v2
  v_lshl_add_u32 v9, v1, 8, v2
  v_add_u32 v9, s10, v9
  v_lshrrev_b32 v1, 4, v0
  v_add_u32 v2, 8, v1
  v_and_b32 v3, 15, v0
  v_xor_b32 v2, v2, v3
  v_lshlrev_b32 v2, 4, v2
  v_lshl_add_u32 v10, v1, 8, v2
  v_add_u32 v10, s10, v10
  v_lshrrev_b32 v1, 4, v0
  v_add_u32 v2, 12, v1
  v_and_b32 v3, 15, v0
  v_xor_b32 v2, v2, v3
  v_lshlrev_b32 v2, 4, v2
  v_lshl_add_u32 v11, v1, 8, v2
  v_add_u32 v11, s10, v11
  v_lshlrev_b32 v14, 4, v0
  v_and_b32 v1, 15, v0
  v_lshrrev_b32 v2, 4, v0
  v_lshrrev_b32 v3, 2, v1
  v_lshrrev_b32 v4, 1, v2
  v_mul_u32_u24 v4, 4, v4
  v_add_u32 v4, v4, v3
  v_and_b32 v5, 1, v2
  v_and_b32 v6, 2, v1
  v_lshl_or_b32 v5, v5, 2, v6
  v_and_b32 v6, 1, v1
  v_lshlrev_b32 v6, 2, v6
  v_xor_b32 v6, v6, v5
  v_and_b32 v3, 1, v3
  v_xor_b32 v6, v6, v3
  v_lshlrev_b32 v6, 4, v6
  v_lshl_add_u32 v6, v5, 7, v6
  v_lshl_add_u32 v16, v4, 10, v6
  v_xor_b32 v17, 16, v16
  v_xor_b32 v18, 32, v16
  v_xor_b32 v19, 48, v16
  v_xor_b32 v20, 144, v16
  v_xor_b32 v21, 128, v16
  v_xor_b32 v22, 176, v16
  v_xor_b32 v23, 160, v16
  s_mov_b32 s43, 0x05040100
  s_mov_b32 s44, 0x07060302
  v_lshlrev_b32 v1, 4, v1
  v_lshl_add_u32 v12, v2, 11, v1
  v_add_u32 v16, s10, v16
  v_add_u32 v17, s10, v17
  v_add_u32 v18, s10, v18
  v_add_u32 v19, s10, v19
  v_add_u32 v20, s10, v20
  v_add_u32 v21, s10, v21
  v_add_u32 v22, s10, v22
  v_add_u32 v23, s10, v23
  s_lshl_b32 s10, s45, 2
  v_add_u32 v13, s10, v31
WW_27:
  ds_read_b64 v[28:29], v31 offset:136
  s_waitcnt lgkmcnt(0)
  v_and_b32 v28, v28, v29
  s_nop 0
  v_readfirstlane_b32 s12, v28
  s_cmp_lg_u32 s12, 0
  s_cbranch_scc1 WD_28
  s_sleep 1
  s_sub_u32 s14, s14, 1
  s_cbranch_scc1 L_ABORT
  s_branch WW_27
WD_28:
  s_mov_b32 s9, 0
  buffer_load_dwordx4 v[64:67], v14, s[32:35], s9 offen offset:0
  buffer_load_dwordx4 v[68:71], v14, s[32:35], s9 offen offset:1024
  buffer_load_dwordx4 v[72:75], v14, s[32:35], s9 offen offset:2048
  buffer_load_dwordx4 v[76:79], v14, s[32:35], s9 offen offset:3072
  s_mov_b32 s9, 4096
  buffer_load_dwordx4 v[80:83], v14, s[32:35], s9 offen offset:0
  buffer_load_dwordx4 v[84:87], v14, s[32:35], s9 offen offset:1024
  buffer_load_dwordx4 v[88:91], v14, s[32:35], s9 offen offset:2048
  buffer_load_dwordx4 v[92:95], v14, s[32:35], s9 offen offset:3072
  s_mov_b32 s9, 8192
  buffer_load_dwordx4 v[96:99], v14, s[32:35], s9 offen offset:0
  buffer_load_dwordx4 v[100:103], v14, s[32:35], s9 offen offset:1024
  buffer_load_dwordx4 v[104:107], v14, s[32:35], s9 offen offset:2048
  buffer_load_dwordx4 v[108:111], v14, s[32:35], s9 offen offset:3072
  s_mov_b32 s9, 12288
  buffer_load_dwordx4 v[112:115], v14, s[32:35], s9 offen offset:0
  buffer_load_dwordx4 v[116:119], v14, s[32:35], s9 offen offset:1024
  buffer_load_dwordx4 v[120:123], v14, s[32:35], s9 offen offset:2048
  buffer_load_dwordx4 v[124:127], v14, s[32:35], s9 offen offset:3072
WW_29:
  ds_read_b64 v[28:29], v31 offset:152
  s_waitcnt lgkmcnt(0)
  v_and_b32 v28, v28, v29
  s_nop 0
  v_readfirstlane_b32 s12, v28
  s_cmp_lg_u32 s12, 0
  s_cbranch_scc1 WD_30
  s_sleep 1
  s_sub_u32 s14, s14, 1
  s_cbranch_scc1 L_ABORT
  s_branch WW_29
WD_30:
  s_mov_b32 s9, 0
  buffer_load_dwordx4 v[128:131], v12, s[88:91], s9 offen offset:0
  buffer_load_dwordx4 v[132:135], v12, s[88:91], s9 offen offset:256
  buffer_load_dwordx4 v[136:139], v12, s[88:91], s9 offen offset:512
  buffer_load_dwordx4 v[140:143], v12, s[88:91], s9 offen offset:768
  buffer_load_dwordx4 v[144:147], v12, s[88:91], s9 offen offset:1024
  buffer_load_dwordx4 v[148:151], v12, s[88:91], s9 offen offset:1280
  buffer_load_dwordx4 v[152:155], v12, s[88:91], s9 offen offset:1536
  buffer_load_dwordx4 v[156:159], v12, s[88:91], s9 offen offset:1792
  s_mov_b32 s9, 8192
  buffer_load_dwordx4 v[160:163], v12, s[88:91], s9 offen offset:0
  buffer_load_dwordx4 v[164:167], v12, s[88:91], s9 offen offset:256
  buffer_load_dwordx4 v[168:171], v12, s[88:91], s9 offen offset:512
  buffer_load_dwordx4 v[172:175], v12, s[88:91], s9 offen offset:768
  buffer_load_dwordx4 v[176:179], v12, s[88:91], s9 offen offset:1024
  buffer_load_dwordx4 v[180:183], v12, s[88:91], s9 offen offset:1280
  buffer_load_dwordx4 v[184:187], v12, s[88:91], s9 offen offset:1536
  buffer_load_dwordx4 v[188:191], v12, s[88:91], s9 offen offset:1792
  buffer_load_dwordx2 v[6:7], v15, s[36:39], 0 offen sc1
  s_mov_b64 exec, 1
  ds_write_b32 v13, v30 offset:200
  s_mov_b64 exec, -1
WP_31:
  ds_read_b128 v[24:27], v31 offset:64
  s_waitcnt lgkmcnt(0)
  v_min_u32 v24, v24, v25
  v_min3_u32 v24, v24, v26, v27
  s_nop 0
  v_readfirstlane_b32 s12, v24
  s_cmp_ge_u32 s12, 5
  s_cbranch_scc1 WD_32
  s_sleep 1
  s_sub_u32 s14, s14, 1
  s_cbranch_scc1 L_ABORT
  s_branch WP_31
WD_32:
  s_waitcnt vmcnt(31)
  ds_write_b128 v8, v[64:67] offset:0
  ds_write_b128 v9, v[68:71] offset:1024
  s_waitcnt vmcnt(29)
  ds_write_b128 v10, v[72:75] offset:2048
  ds_write_b128 v11, v[76:79] offset:3072
  s_waitcnt vmcnt(27)
  ds_write_b128 v8, v[80:83] offset:4096
  ds_write_b128 v9, v[84:87] offset:5120
  s_waitcnt vmcnt(25)
  ds_write_b128 v10, v[88:91] offset:6144
  ds_write_b128 v11, v[92:95] offset:7168
  s_waitcnt vmcnt(23)
  ds_write_b128 v8, v[96:99] offset:8192
  ds_write_b128 v9, v[100:103] offset:9216
  s_waitcnt vmcnt(21)
  ds_write_b128 v10, v[104:107] offset:10240
  ds_write_b128 v11, v[108:111] offset:11264
  s_waitcnt vmcnt(19)
  ds_write_b128 v8, v[112:115] offset:12288
  ds_write_b128 v9, v[116:119] offset:13312
  s_waitcnt vmcnt(17)
  ds_write_b128 v10, v[120:123] offset:14336
  ds_write_b128 v11, v[124:127] offset:15360
  s_mov_b64 exec, 1
  ds_write_b32 v13, v30 offset:80
  s_mov_b64 exec, -1
WP_33:
  ds_read_b128 v[24:27], v31 offset:64
  s_waitcnt lgkmcnt(0)
  v_min_u32 v24, v24, v25
  v_min3_u32 v24, v24, v26, v27
  s_nop 0
  v_readfirstlane_b32 s12, v24
  s_cmp_ge_u32 s12, 6
  s_cbranch_scc1 WD_34
  s_sleep 1
  s_sub_u32 s14, s14, 1
  s_cbranch_scc1 L_ABORT
  s_branch WP_33
WD_34:
  s_waitcnt vmcnt(9)
  v_perm_b32 v32, v132, v128, s43
  v_perm_b32 v33, v140, v136, s43
  v_perm_b32 v34, v148, v144, s43
  v_perm_b32 v35, v156, v152, s43
  ds_write_b128 v16, v[32:35] offset:32768
  v_perm_b32 v36, v132, v128, s44
  v_perm_b32 v37, v140, v136, s44
  v_perm_b32 v38, v148, v144, s44
  v_perm_b32 v39, v156, v152, s44
  ds_write_b128 v17, v[36:39] offset:32768
  v_perm_b32 v40, v133, v129, s43
  v_perm_b32 v41, v141, v137, s43
  v_perm_b32 v42, v149, v145, s43
  v_perm_b32 v43, v157, v153, s43
  ds_write_b128 v18, v[40:43] offset:32768
  v_perm_b32 v44, v133, v129, s44
  v_perm_b32 v45, v141, v137, s44
  v_perm_b32 v46, v149, v145, s44
  v_perm_b32 v47, v157, v153, s44
  ds_write_b128 v19, v[44:47] offset:32768
  v_perm_b32 v48, v134, v130, s43
  v_perm_b32 v49, v142, v138, s43
  v_perm_b32 v50, v150, v146, s43
  v_perm_b32 v51, v158, v154, s43
  ds_write_b128 v20, v[48:51] offset:32768
  v_perm_b32 v52, v134, v130, s44
  v_perm_b32 v53, v142, v138, s44
  v_perm_b32 v54, v150, v146, s44
  v_perm_b32 v55, v158, v154, s44
  ds_write_b128 v21, v[52:55] offset:32768
  v_perm_b32 v56, v135, v131, s43
  v_perm_b32 v57, v143, v139, s43
  v_perm_b32 v58, v151, v147, s43
  v_perm_b32 v59, v159, v155, s43
  ds_write_b128 v22, v[56:59] offset:32768
  v_perm_b32 v60, v135, v131, s44
  v_perm_b32 v61, v143, v139, s44
  v_perm_b32 v62, v151, v147, s44
  v_perm_b32 v63, v159, v155, s44
  ds_write_b128 v23, v[60:63] offset:32768
  s_waitcnt vmcnt(1)
  v_perm_b32 v32, v164, v160, s43
  v_perm_b32 v33, v172, v168, s43
  v_perm_b32 v34, v180, v176, s43
  v_perm_b32 v35, v188, v184, s43
  ds_write_b128 v16, v[32:35] offset:40960
  v_perm_b32 v36, v164, v160, s44
  v_perm_b32 v37, v172, v168, s44
  v_perm_b32 v38, v180, v176, s44
  v_perm_b32 v39, v188, v184, s44
  ds_write_b128 v17, v[36:39] offset:40960
  v_perm_b32 v40, v165, v161, s43
  v_perm_b32 v41, v173, v169, s43
  v_perm_b32 v42, v181, v177, s43
  v_perm_b32 v43, v189, v185, s43
  ds_write_b128 v18, v[40:43] offset:40960
  v_perm_b32 v44, v165, v161, s44
  v_perm_b32 v45, v173, v169, s44
  v_perm_b32 v46, v181, v177, s44
  v_perm_b32 v47, v189, v185, s44
  ds_write_b128 v19, v[44:47] offset:40960
  v_perm_b32 v48, v166, v162, s43
  v_perm_b32 v49, v174, v170, s43
  v_perm_b32 v50, v182, v178, s43
  v_perm_b32 v51, v190, v186, s43
  ds_write_b128 v20, v[48:51] offset:40960
  v_perm_b32 v52, v166, v162, s44
  v_perm_b32 v53, v174, v170, s44
  v_perm_b32 v54, v182, v178, s44
  v_perm_b32 v55, v190, v186, s44
  ds_write_b128 v21, v[52:55] offset:40960
  v_perm_b32 v56, v167, v163, s43
  v_perm_b32 v57, v175, v171, s43
  v_perm_b32 v58, v183, v179, s43
  v_perm_b32 v59, v191, v187, s43
  ds_write_b128 v22, v[56:59] offset:40960
  v_perm_b32 v60, v167, v163, s44
  v_perm_b32 v61, v175, v171, s44
  v_perm_b32 v62, v183, v179, s44
  v_perm_b32 v63, v191, v187, s44
  ds_write_b128 v23, v[60:63] offset:40960
  s_mov_b64 exec, 1
  ds_write_b32 v13, v30 offset:88
  s_mov_b64 exec, -1
  s_waitcnt vmcnt(0)
  s_mov_b32 s54, 11
  s_cmp_eq_u32 s45, 0
  s_cbranch_scc1 L_KV6
L_NCHK:
  v_readfirstlane_b32 s9, v6
  s_cmp_lg_u32 s9, 0
  s_cbranch_scc1 L_NGOT
  buffer_load_dwordx2 v[6:7], v15, s[36:39], 0 offen sc1
  s_waitcnt vmcnt(0)
  s_sub_u32 s14, s14, 1
  s_cbranch_scc1 L_ABORT
  s_branch L_NCHK
L_NGOT:
  s_mov_b64 exec, 1
  ds_write_b64 v31, v[6:7] offset:192
  s_mov_b64 exec, -1
  s_mov_b32 s48, 5
  s_mov_b32 s49, 0
  s_mov_b32 s50, 9
  s_mov_b32 s51, 7
  s_mov_b32 s52, 32768
  s_mov_b32 s53, 10
  s_branch L_WO
L_KV6:
  s_mov_b32 s48, 4
  s_mov_b32 s49, 114688
  s_mov_b32 s50, 8
  s_mov_b32 s51, 6
  s_mov_b32 s52, 16384
  s_mov_b32 s53, 9
L_WO:
  s_lshl_b32 s9, s4, 20
  s_lshl_b32 s10, s6, 7
  s_add_u32 s9, s9, s10
  s_add_u32 s32, s24, s9
  s_addc_u32 s33, s25, 0
  s_and_b32 s33, s33, 0xffff
  s_sub_u32 s34, 4194304, s9
  s_mov_b32 s35, 0x20000
  v_and_b32 v1, 7, v0
  v_lshrrev_b32 v2, 3, v0
  v_lshlrev_b32 v1, 4, v1
  v_lshl_add_u32 v12, v2, 13, v1
  v_add_u32 v13, 4096, v12
  v_and_b32 v1, 7, v0
  v_lshrrev_b32 v2, 3, v0
  v_lshrrev_b32 v3, 2, v1
  v_lshrrev_b32 v4, 1, v2
  v_mul_u32_u24 v4, 2, v4
  v_add_u32 v4, v4, v3
  v_and_b32 v5, 1, v2
  v_and_b32 v6, 2, v1
  v_lshl_or_b32 v5, v5, 2, v6
  v_and_b32 v6, 1, v1
  v_lshlrev_b32 v6, 2, v6
  v_xor_b32 v6, v6, v5
  v_and_b32 v3, 1, v3
  v_xor_b32 v6, v6, v3
  v_lshlrev_b32 v6, 4, v6
  v_lshl_add_u32 v6, v5, 7, v6
  v_lshl_add_u32 v16, v4, 10, v6
  v_xor_b32 v17, 16, v16
  v_xor_b32 v18, 32, v16
  v_xor_b32 v19, 48, v16
  v_xor_b32 v20, 144, v16
  v_xor_b32 v21, 128, v16
  v_xor_b32 v22, 176, v16
  v_xor_b32 v23, 160, v16
  s_mov_b32 s43, 0x05040100
  s_mov_b32 s44, 0x07060302
WW_35:
  ds_read_b64 v[28:29], v31 offset:200
  s_waitcnt lgkmcnt(0)
  v_and_b32 v28, v28, v29
  s_nop 0
  v_readfirstlane_b32 s12, v28
  s_cmp_lg_u32 s12, 0
  s_cbranch_scc1 WD_36
  s_sleep 1
  s_sub_u32 s14, s14, 1
  s_cbranch_scc1 L_ABORT
  s_branch WW_35
WD_36:
WP_37:
  ds_read_b128 v[24:27], v31 offset:64
  s_waitcnt lgkmcnt(0)
  v_min_u32 v24, v24, v25
  v_min3_u32 v24, v24, v26, v27
  s_nop 0
  v_readfirstlane_b32 s12, v24
  s_cmp_ge_u32 s12, s54
  s_cbranch_scc1 WD_38
  s_sleep 1
  s_sub_u32 s14, s14, 1
  s_cbranch_scc1 L_ABORT
  s_branch WP_37
WD_38:
  s_mul_i32 s9, s15, s48
  s_add_u32 s9, s6, s9
  s_and_b32 s9, s9, 7
  s_lshl_b32 s9, s9, 17
  buffer_load_dwordx4 v[64:67], v12, s[32:35], s9 offen offset:0
  buffer_load_dwordx4 v[68:71], v12, s[32:35], s9 offen offset:1024
  buffer_load_dwordx4 v[72:75], v12, s[32:35], s9 offen offset:2048
  buffer_load_dwordx4 v[76:79], v12, s[32:35], s9 offen offset:3072
  buffer_load_dwordx4 v[80:83], v13, s[32:35], s9 offen offset:0
  buffer_load_dwordx4 v[84:87], v13, s[32:35], s9 offen offset:1024
  buffer_load_dwordx4 v[88:91], v13, s[32:35], s9 offen offset:2048
  buffer_load_dwordx4 v[92:95], v13, s[32:35], s9 offen offset:3072
  s_add_u32 s9, s9, 65536
  buffer_load_dwordx4 v[96:99], v12, s[32:35], s9 offen offset:0
  buffer_load_dwordx4 v[100:103], v12, s[32:35], s9 offen offset:1024
  buffer_load_dwordx4 v[104:107], v12, s[32:35], s9 offen offset:2048
  buffer_load_dwordx4 v[108:111], v12, s[32:35], s9 offen offset:3072
  buffer_load_dwordx4 v[112:115], v13, s[32:35], s9 offen offset:0
  buffer_load_dwordx4 v[116:119], v13, s[32:35], s9 offen offset:1024
  buffer_load_dwordx4 v[120:123], v13, s[32:35], s9 offen offset:2048
  buffer_load_dwordx4 v[124:127], v13, s[32:35], s9 offen offset:3072
  ds_read_b128 v[24:27], v31 offset:64
  s_waitcnt lgkmcnt(0)
  v_max_u32 v28, v24, v25
  v_max3_u32 v28, v28, v26, v27
  v_min_u32 v24, v24, v25
  v_min3_u32 v24, v24, v26, v27
  v_readfirstlane_b32 s11, v28
  v_readfirstlane_b32 s12, v24
  s_cmp_lt_u32 s11, 9
  s_cbranch_scc1 L_WOE
  s_cmp_ge_u32 s12, 11
  s_cbranch_scc1 L_WOE
WP_39:
  ds_read_b128 v[24:27], v31 offset:64
  s_waitcnt lgkmcnt(0)
  v_min_u32 v24, v24, v25
  v_min3_u32 v24, v24, v26, v27
  s_nop 0
  v_readfirstlane_b32 s12, v24
  s_cmp_ge_u32 s12, s50
  s_cbranch_scc1 WD_40
  s_sleep 1
  s_sub_u32 s14, s14, 1
  s_cbranch_scc1 L_ABORT
  s_branch WP_39
WD_40:
  v_add_u32 v192, s49, v16
  v_add_u32 v193, s49, v17
  v_add_u32 v194, s49, v18
  v_add_u32 v195, s49, v19
  v_add_u32 v196, s49, v20
  v_add_u32 v197, s49, v21
  v_add_u32 v198, s49, v22
  v_add_u32 v199, s49, v23
  s_waitcnt vmcnt(8)
  v_perm_b32 v32, v68, v64, s43
  v_perm_b32 v33, v76, v72, s43
  v_perm_b32 v34, v84, v80, s43
  v_perm_b32 v35, v92, v88, s43
  ds_write_b128 v192, v[32:35] offset:0
  v_perm_b32 v36, v68, v64, s44
  v_perm_b32 v37, v76, v72, s44
  v_perm_b32 v38, v84, v80, s44
  v_perm_b32 v39, v92, v88, s44
  ds_write_b128 v193, v[36:39] offset:0
  v_perm_b32 v40, v69, v65, s43
  v_perm_b32 v41, v77, v73, s43
  v_perm_b32 v42, v85, v81, s43
  v_perm_b32 v43, v93, v89, s43
  ds_write_b128 v194, v[40:43] offset:0
  v_perm_b32 v44, v69, v65, s44
  v_perm_b32 v45, v77, v73, s44
  v_perm_b32 v46, v85, v81, s44
  v_perm_b32 v47, v93, v89, s44
  ds_write_b128 v195, v[44:47] offset:0
  v_perm_b32 v48, v70, v66, s43
  v_perm_b32 v49, v78, v74, s43
  v_perm_b32 v50, v86, v82, s43
  v_perm_b32 v51, v94, v90, s43
  ds_write_b128 v196, v[48:51] offset:0
  v_perm_b32 v52, v70, v66, s44
  v_perm_b32 v53, v78, v74, s44
  v_perm_b32 v54, v86, v82, s44
  v_perm_b32 v55, v94, v90, s44
  ds_write_b128 v197, v[52:55] offset:0
  v_perm_b32 v56, v71, v67, s43
  v_perm_b32 v57, v79, v75, s43
  v_perm_b32 v58, v87, v83, s43
  v_perm_b32 v59, v95, v91, s43
  ds_write_b128 v198, v[56:59] offset:0
  v_perm_b32 v60, v71, v67, s44
  v_perm_b32 v61, v79, v75, s44
  v_perm_b32 v62, v87, v83, s44
  v_perm_b32 v63, v95, v91, s44
  ds_write_b128 v199, v[60:63] offset:0
  s_waitcnt vmcnt(0)
  v_perm_b32 v32, v100, v96, s43
  v_perm_b32 v33, v108, v104, s43
  v_perm_b32 v34, v116, v112, s43
  v_perm_b32 v35, v124, v120, s43
  ds_write_b128 v192, v[32:35] offset:8192
  v_perm_b32 v36, v100, v96, s44
  v_perm_b32 v37, v108, v104, s44
  v_perm_b32 v38, v116, v112, s44
  v_perm_b32 v39, v124, v120, s44
  ds_write_b128 v193, v[36:39] offset:8192
  v_perm_b32 v40, v101, v97, s43
  v_perm_b32 v41, v109, v105, s43
  v_perm_b32 v42, v117, v113, s43
  v_perm_b32 v43, v125, v121, s43
  ds_write_b128 v194, v[40:43] offset:8192
  v_perm_b32 v44, v101, v97, s44
  v_perm_b32 v45, v109, v105, s44
  v_perm_b32 v46, v117, v113, s44
  v_perm_b32 v47, v125, v121, s44
  ds_write_b128 v195, v[44:47] offset:8192
  v_perm_b32 v48, v102, v98, s43
  v_perm_b32 v49, v110, v106, s43
  v_perm_b32 v50, v118, v114, s43
  v_perm_b32 v51, v126, v122, s43
  ds_write_b128 v196, v[48:51] offset:8192
  v_perm_b32 v52, v102, v98, s44
  v_perm_b32 v53, v110, v106, s44
  v_perm_b32 v54, v118, v114, s44
  v_perm_b32 v55, v126, v122, s44
  ds_write_b128 v197, v[52:55] offset:8192
  v_perm_b32 v56, v103, v99, s43
  v_perm_b32 v57, v111, v107, s43
  v_perm_b32 v58, v119, v115, s43
  v_perm_b32 v59, v127, v123, s43
  ds_write_b128 v198, v[56:59] offset:8192
  v_perm_b32 v60, v103, v99, s44
  v_perm_b32 v61, v111, v107, s44
  v_perm_b32 v62, v119, v115, s44
  v_perm_b32 v63, v127, v123, s44
  ds_write_b128 v199, v[60:63] offset:8192
  s_lshl_b32 s9, s48, 2
  v_add_u32 v24, s9, v31
  s_mov_b64 exec, 1
  ds_write_b32 v24, v30 offset:160
  s_mov_b64 exec, -1
WP_41:
  ds_read_b128 v[24:27], v31 offset:64
  s_waitcnt lgkmcnt(0)
  v_min_u32 v24, v24, v25
  v_min3_u32 v24, v24, v26, v27
  s_nop 0
  v_readfirstlane_b32 s12, v24
  s_cmp_ge_u32 s12, 11
  s_cbranch_scc1 WD_42
  s_sleep 1
  s_sub_u32 s14, s14, 1
  s_cbranch_scc1 L_ABORT
  s_branch WP_41
WD_42:
  s_mul_i32 s9, s15, s51
  s_add_u32 s9, s6, s9
  s_and_b32 s9, s9, 7
  s_lshl_b32 s9, s9, 17
  buffer_load_dwordx4 v[128:131], v12, s[32:35], s9 offen offset:0
  buffer_load_dwordx4 v[132:135], v12, s[32:35], s9 offen offset:1024
  buffer_load_dwordx4 v[136:139], v12, s[32:35], s9 offen offset:2048
  buffer_load_dwordx4 v[140:143], v12, s[32:35], s9 offen offset:3072
  buffer_load_dwordx4 v[144:147], v13, s[32:35], s9 offen offset:0
  buffer_load_dwordx4 v[148:151], v13, s[32:35], s9 offen offset:1024
  buffer_load_dwordx4 v[152:155], v13, s[32:35], s9 offen offset:2048
  buffer_load_dwordx4 v[156:159], v13, s[32:35], s9 offen offset:3072
  s_add_u32 s9, s9, 65536
  buffer_load_dwordx4 v[160:163], v12, s[32:35], s9 offen offset:0
  buffer_load_dwordx4 v[164:167], v12, s[32:35], s9 offen offset:1024
  buffer_load_dwordx4 v[168:171], v12, s[32:35], s9 offen offset:2048
  buffer_load_dwordx4 v[172:175], v12, s[32:35], s9 offen offset:3072
  buffer_load_dwordx4 v[176:179], v13, s[32:35], s9 offen offset:0
  buffer_load_dwordx4 v[180:183], v13, s[32:35], s9 offen offset:1024
  buffer_load_dwordx4 v[184:187], v13, s[32:35], s9 offen offset:2048
  buffer_load_dwordx4 v[188:191], v13, s[32:35], s9 offen offset:3072
  s_branch L_WOB
L_WOE:
  s_mul_i32 s9, s15, s51
  s_add_u32 s9, s6, s9
  s_and_b32 s9, s9, 7
  s_lshl_b32 s9, s9, 17
  buffer_load_dwordx4 v[128:131], v12, s[32:35], s9 offen offset:0
  buffer_load_dwordx4 v[132:135], v12, s[32:35], s9 offen offset:1024
  buffer_load_dwordx4 v[136:139], v12, s[32:35], s9 offen offset:2048
  buffer_load_dwordx4 v[140:143], v12, s[32:35], s9 offen offset:3072
  buffer_load_dwordx4 v[144:147], v13, s[32:35], s9 offen offset:0
  buffer_load_dwordx4 v[148:151], v13, s[32:35], s9 offen offset:1024
  buffer_load_dwordx4 v[152:155], v13, s[32:35], s9 offen offset:2048
  buffer_load_dwordx4 v[156:159], v13, s[32:35], s9 offen offset:3072
  s_add_u32 s9, s9, 65536
  buffer_load_dwordx4 v[160:163], v12, s[32:35], s9 offen offset:0
  buffer_load_dwordx4 v[164:167], v12, s[32:35], s9 offen offset:1024
  buffer_load_dwordx4 v[168:171], v12, s[32:35], s9 offen offset:2048
  buffer_load_dwordx4 v[172:175], v12, s[32:35], s9 offen offset:3072
  buffer_load_dwordx4 v[176:179], v13, s[32:35], s9 offen offset:0
  buffer_load_dwordx4 v[180:183], v13, s[32:35], s9 offen offset:1024
  buffer_load_dwordx4 v[184:187], v13, s[32:35], s9 offen offset:2048
  buffer_load_dwordx4 v[188:191], v13, s[32:35], s9 offen offset:3072
WP_43:
  ds_read_b128 v[24:27], v31 offset:64
  s_waitcnt lgkmcnt(0)
  v_min_u32 v24, v24, v25
  v_min3_u32 v24, v24, v26, v27
  s_nop 0
  v_readfirstlane_b32 s12, v24
  s_cmp_ge_u32 s12, s50
  s_cbranch_scc1 WD_44
  s_sleep 1
  s_sub_u32 s14, s14, 1
  s_cbranch_scc1 L_ABORT
  s_branch WP_43
WD_44:
  v_add_u32 v192, s49, v16
  v_add_u32 v193, s49, v17
  v_add_u32 v194, s49, v18
  v_add_u32 v195, s49, v19
  v_add_u32 v196, s49, v20
  v_add_u32 v197, s49, v21
  v_add_u32 v198, s49, v22
  v_add_u32 v199, s49, v23
  s_waitcnt vmcnt(24)
  v_perm_b32 v32, v68, v64, s43
  v_perm_b32 v33, v76, v72, s43
  v_perm_b32 v34, v84, v80, s43
  v_perm_b32 v35, v92, v88, s43
  ds_write_b128 v192, v[32:35] offset:0
  v_perm_b32 v36, v68, v64, s44
  v_perm_b32 v37, v76, v72, s44
  v_perm_b32 v38, v84, v80, s44
  v_perm_b32 v39, v92, v88, s44
  ds_write_b128 v193, v[36:39] offset:0
  v_perm_b32 v40, v69, v65, s43
  v_perm_b32 v41, v77, v73, s43
  v_perm_b32 v42, v85, v81, s43
  v_perm_b32 v43, v93, v89, s43
  ds_write_b128 v194, v[40:43] offset:0
  v_perm_b32 v44, v69, v65, s44
  v_perm_b32 v45, v77, v73, s44
  v_perm_b32 v46, v85, v81, s44
  v_perm_b32 v47, v93, v89, s44
  ds_write_b128 v195, v[44:47] offset:0
  v_perm_b32 v48, v70, v66, s43
  v_perm_b32 v49, v78, v74, s43
  v_perm_b32 v50, v86, v82, s43
  v_perm_b32 v51, v94, v90, s43
  ds_write_b128 v196, v[48:51] offset:0
  v_perm_b32 v52, v70, v66, s44
  v_perm_b32 v53, v78, v74, s44
  v_perm_b32 v54, v86, v82, s44
  v_perm_b32 v55, v94, v90, s44
  ds_write_b128 v197, v[52:55] offset:0
  v_perm_b32 v56, v71, v67, s43
  v_perm_b32 v57, v79, v75, s43
  v_perm_b32 v58, v87, v83, s43
  v_perm_b32 v59, v95, v91, s43
  ds_write_b128 v198, v[56:59] offset:0
  v_perm_b32 v60, v71, v67, s44
  v_perm_b32 v61, v79, v75, s44
  v_perm_b32 v62, v87, v83, s44
  v_perm_b32 v63, v95, v91, s44
  ds_write_b128 v199, v[60:63] offset:0
  s_waitcnt vmcnt(16)
  v_perm_b32 v32, v100, v96, s43
  v_perm_b32 v33, v108, v104, s43
  v_perm_b32 v34, v116, v112, s43
  v_perm_b32 v35, v124, v120, s43
  ds_write_b128 v192, v[32:35] offset:8192
  v_perm_b32 v36, v100, v96, s44
  v_perm_b32 v37, v108, v104, s44
  v_perm_b32 v38, v116, v112, s44
  v_perm_b32 v39, v124, v120, s44
  ds_write_b128 v193, v[36:39] offset:8192
  v_perm_b32 v40, v101, v97, s43
  v_perm_b32 v41, v109, v105, s43
  v_perm_b32 v42, v117, v113, s43
  v_perm_b32 v43, v125, v121, s43
  ds_write_b128 v194, v[40:43] offset:8192
  v_perm_b32 v44, v101, v97, s44
  v_perm_b32 v45, v109, v105, s44
  v_perm_b32 v46, v117, v113, s44
  v_perm_b32 v47, v125, v121, s44
  ds_write_b128 v195, v[44:47] offset:8192
  v_perm_b32 v48, v102, v98, s43
  v_perm_b32 v49, v110, v106, s43
  v_perm_b32 v50, v118, v114, s43
  v_perm_b32 v51, v126, v122, s43
  ds_write_b128 v196, v[48:51] offset:8192
  v_perm_b32 v52, v102, v98, s44
  v_perm_b32 v53, v110, v106, s44
  v_perm_b32 v54, v118, v114, s44
  v_perm_b32 v55, v126, v122, s44
  ds_write_b128 v197, v[52:55] offset:8192
  v_perm_b32 v56, v103, v99, s43
  v_perm_b32 v57, v111, v107, s43
  v_perm_b32 v58, v119, v115, s43
  v_perm_b32 v59, v127, v123, s43
  ds_write_b128 v198, v[56:59] offset:8192
  v_perm_b32 v60, v103, v99, s44
  v_perm_b32 v61, v111, v107, s44
  v_perm_b32 v62, v119, v115, s44
  v_perm_b32 v63, v127, v123, s44
  ds_write_b128 v199, v[60:63] offset:8192
  s_lshl_b32 s9, s48, 2
  v_add_u32 v24, s9, v31
  s_mov_b64 exec, 1
  ds_write_b32 v24, v30 offset:160
  s_mov_b64 exec, -1
L_WOB:
WP_45:
  ds_read_b128 v[24:27], v31 offset:64
  s_waitcnt lgkmcnt(0)
  v_min_u32 v24, v24, v25
  v_min3_u32 v24, v24, v26, v27
  s_nop 0
  v_readfirstlane_b32 s12, v24
  s_cmp_ge_u32 s12, s53
  s_cbranch_scc1 WD_46
  s_sleep 1
  s_sub_u32 s14, s14, 1
  s_cbranch_scc1 L_ABORT
  s_branch WP_45
WD_46:
  v_add_u32 v192, s52, v16
  v_add_u32 v193, s52, v17
  v_add_u32 v194, s52, v18
  v_add_u32 v195, s52, v19
  v_add_u32 v196, s52, v20
  v_add_u32 v197, s52, v21
  v_add_u32 v198, s52, v22
  v_add_u32 v199, s52, v23
  s_waitcnt vmcnt(8)
  v_perm_b32 v32, v132, v128, s43
  v_perm_b32 v33, v140, v136, s43
  v_perm_b32 v34, v148, v144, s43
  v_perm_b32 v35, v156, v152, s43
  ds_write_b128 v192, v[32:35] offset:0
  v_perm_b32 v36, v132, v128, s44
  v_perm_b32 v37, v140, v136, s44
  v_perm_b32 v38, v148, v144, s44
  v_perm_b32 v39, v156, v152, s44
  ds_write_b128 v193, v[36:39] offset:0
  v_perm_b32 v40, v133, v129, s43
  v_perm_b32 v41, v141, v137, s43
  v_perm_b32 v42, v149, v145, s43
  v_perm_b32 v43, v157, v153, s43
  ds_write_b128 v194, v[40:43] offset:0
  v_perm_b32 v44, v133, v129, s44
  v_perm_b32 v45, v141, v137, s44
  v_perm_b32 v46, v149, v145, s44
  v_perm_b32 v47, v157, v153, s44
  ds_write_b128 v195, v[44:47] offset:0
  v_perm_b32 v48, v134, v130, s43
  v_perm_b32 v49, v142, v138, s43
  v_perm_b32 v50, v150, v146, s43
  v_perm_b32 v51, v158, v154, s43
  ds_write_b128 v196, v[48:51] offset:0
  v_perm_b32 v52, v134, v130, s44
  v_perm_b32 v53, v142, v138, s44
  v_perm_b32 v54, v150, v146, s44
  v_perm_b32 v55, v158, v154, s44
  ds_write_b128 v197, v[52:55] offset:0
  v_perm_b32 v56, v135, v131, s43
  v_perm_b32 v57, v143, v139, s43
  v_perm_b32 v58, v151, v147, s43
  v_perm_b32 v59, v159, v155, s43
  ds_write_b128 v198, v[56:59] offset:0
  v_perm_b32 v60, v135, v131, s44
  v_perm_b32 v61, v143, v139, s44
  v_perm_b32 v62, v151, v147, s44
  v_perm_b32 v63, v159, v155, s44
  ds_write_b128 v199, v[60:63] offset:0
  s_waitcnt vmcnt(0)
  v_perm_b32 v32, v164, v160, s43
  v_perm_b32 v33, v172, v168, s43
  v_perm_b32 v34, v180, v176, s43
  v_perm_b32 v35, v188, v184, s43
  ds_write_b128 v192, v[32:35] offset:8192
  v_perm_b32 v36, v164, v160, s44
  v_perm_b32 v37, v172, v168, s44
  v_perm_b32 v38, v180, v176, s44
  v_perm_b32 v39, v188, v184, s44
  ds_write_b128 v193, v[36:39] offset:8192
  v_perm_b32 v40, v165, v161, s43
  v_perm_b32 v41, v173, v169, s43
  v_perm_b32 v42, v181, v177, s43
  v_perm_b32 v43, v189, v185, s43
  ds_write_b128 v194, v[40:43] offset:8192
  v_perm_b32 v44, v165, v161, s44
  v_perm_b32 v45, v173, v169, s44
  v_perm_b32 v46, v181, v177, s44
  v_perm_b32 v47, v189, v185, s44
  ds_write_b128 v195, v[44:47] offset:8192
  v_perm_b32 v48, v166, v162, s43
  v_perm_b32 v49, v174, v170, s43
  v_perm_b32 v50, v182, v178, s43
  v_perm_b32 v51, v190, v186, s43
  ds_write_b128 v196, v[48:51] offset:8192
  v_perm_b32 v52, v166, v162, s44
  v_perm_b32 v53, v174, v170, s44
  v_perm_b32 v54, v182, v178, s44
  v_perm_b32 v55, v190, v186, s44
  ds_write_b128 v197, v[52:55] offset:8192
  v_perm_b32 v56, v167, v163, s43
  v_perm_b32 v57, v175, v171, s43
  v_perm_b32 v58, v183, v179, s43
  v_perm_b32 v59, v191, v187, s43
  ds_write_b128 v198, v[56:59] offset:8192
  v_perm_b32 v60, v167, v163, s44
  v_perm_b32 v61, v175, v171, s44
  v_perm_b32 v62, v183, v179, s44
  v_perm_b32 v63, v191, v187, s44
  ds_write_b128 v199, v[60:63] offset:8192
  s_lshl_b32 s9, s51, 2
  v_add_u32 v24, s9, v31
  s_mov_b64 exec, 1
  ds_write_b32 v24, v30 offset:160
  s_mov_b64 exec, -1
  s_endpgm
L_ABORT:
L_END:
  s_endpgm
L_CODE_END:
.fill 320, 4, 0xbf810000
.set CODE_BYTES, L_CODE_END - standalone__gqa_block_cached__near_ridge_kernel
.section .rodata,"a"
.p2align 6
.amdhsa_kernel standalone__gqa_block_cached__near_ridge_kernel
  .amdhsa_next_free_vgpr 256
  .amdhsa_next_free_sgpr 102
  .amdhsa_accum_offset 256
  .amdhsa_group_segment_fixed_size 0
  .amdhsa_kernarg_size 64
  .amdhsa_user_sgpr_count 2
  .amdhsa_user_sgpr_kernarg_segment_ptr 1
  .amdhsa_system_sgpr_workgroup_id_x 1
.end_amdhsa_kernel
```
